```python
import torch

def _softmax(x, axis=-1):
    return torch.softmax(x, dim=axis)
def _gelu(x):
    return torch.nn.functional.gelu(x, approximate="tanh")
def _silu(x):
    return torch.nn.functional.silu(x)
def _sigmoid(x):
    return torch.sigmoid(x)
def _layernorm(x, axis=-1, eps=1e-5):
    m = x.mean(dim=axis, keepdim=True)
    v = x.var(dim=axis, keepdim=True, unbiased=False)
    return (x - m) / torch.sqrt(v + eps)
def _scatter_add(tgt, idx, src, axis=0):
    return tgt.clone().index_add_(axis, idx, src)
def _segment_sum(src, seg, n):
    out = torch.zeros((n,) + src.shape[1:], dtype=src.dtype)
    return out.index_add_(0, seg, src)
def _pad(x, pw):
    flat = tuple(v for pair in reversed(pw) for v in pair)
    return torch.nn.functional.pad(x, flat)

kernel_name = 'parallel_sum__ssm_conv_h3__mixer_s_mlp__prompt'

def setup_inputs():

    _w = (lambda a: (lambda t: t.to(torch.bfloat16) if t.is_floating_point() else t)(torch.as_tensor(a)))
    def _A_setup():
        B, S, D = 1, 2048, 448
        ks = 4
        return {
            "q": _w((lambda *s: torch.randn(*s, dtype=torch.bfloat16) * 0.05)(B, S, D)),
            "k": _w((lambda *s: torch.randn(*s, dtype=torch.bfloat16) * 0.8)(B, S, D)),
            "v": _w((lambda *s: torch.randn(*s, dtype=torch.bfloat16) * 0.8)(B, S, D)),
            "shift_k": _w((lambda *s: torch.randn(*s, dtype=torch.bfloat16) * 0.8)(D, ks) * 0.5),
            "ssm_k": _w((lambda *s: torch.randn(*s, dtype=torch.bfloat16) * 1.6)(D, S) * (1.0 / S ** 0.5)),
            "ssm_D": _w((lambda *s: torch.randn(*s, dtype=torch.bfloat16) * 0.8)(D)),
        }
    _A_in = _A_setup()

    def _B_setup():
        B, S, D, F = 1, 2048, 448, 1792
        return {
            "x":  _w((lambda *s: torch.randn(*s, dtype=torch.bfloat16) * 0.05)(B, S, D)),
            "w1": _w((lambda *s: torch.randn(*s, dtype=torch.bfloat16) * 3.2)(D, D) * (D ** -0.5)),
            "w2": _w((lambda *s: torch.randn(*s, dtype=torch.bfloat16) * 3.2)(D, D) * (D ** -0.5)),
            "w3": _w((lambda *s: torch.randn(*s, dtype=torch.bfloat16) * 3.2)(D, F) * (D ** -0.5)),
            "w4": _w((lambda *s: torch.randn(*s, dtype=torch.bfloat16) * 1.6)(F, D) * (F ** -0.5)),
        }
    _B_in = _B_setup()

    return {
        "A_q": _A_in["q"],
        "A_k": _A_in["k"],
        "A_v": _A_in["v"],
        "A_shift_k": _A_in["shift_k"],
        "A_ssm_k": _A_in["ssm_k"],
        "A_ssm_D": _A_in["ssm_D"],
        "B_x": _B_in["x"],
        "B_w1": _B_in["w1"],
        "B_w2": _B_in["w2"],
        "B_w3": _B_in["w3"],
        "B_w4": _B_in["w4"],
    }

def reference(A_q, A_k, A_v, A_shift_k, A_ssm_k, A_ssm_D, B_x, B_w1, B_w2, B_w3, B_w4):
    def _A_ref(q, k, v, shift_k, ssm_k, ssm_D):
        B, S, D = q.shape
        ks = shift_k.shape[-1]
        k_pad = _pad(k, ((0, 0), (ks - 1, 0), (0, 0)))
        k_shift = torch.zeros_like(k)
        for t in range(ks):
            k_shift = k_shift + k_pad[:, t:t + S, :] * shift_k[:, ks - 1 - t][None, None, :]
        kv = k_shift * v
        L = 2 * S
        kv_pad = _pad(kv, ((0, 0), (0, S), (0, 0)))
        kf_pad = _pad(ssm_k, ((0, 0), (0, S)))
        kv_f = (lambda x, axes=(-2,-1): torch.fft.rfft2(x.float(), dim=axes))(kv_pad[:, None, :, :], axes=(1, 2))
        kf_f = (lambda x, axes=(-2,-1): torch.fft.rfft2(x.float(), dim=axes))(kf_pad[:, None, :], axes=(1, 2))
        kf_f = (lambda x, *d: x.permute(*d))(kf_f, 1, 2, 0)
        y_f = kv_f * kf_f[None, :, :, :]
        y = (lambda x, s, axes=(-2,-1): torch.fft.irfft2(x, s=s, dim=axes).to(torch.bfloat16))(y_f, (1, L), axes=(1, 2))[:, 0, :S, :]
        y = y + kv * ssm_D[None, None, :]
        return q * y

    def _B_ref(x, w1, w2, w3, w4):
        B, S, D = x.shape
        h = _gelu(_layernorm(x, axis=-1) @ w1)
        c = D // 4
        g0 = _pad(h[:, :, 0*c:1*c], ((0, 0), (1, 0), (0, 0)))[:, :S, :]
        g1 = _pad(h[:, :, 1*c:2*c], ((0, 0), (0, 1), (0, 0)))[:, 1:, :]
        g2 = _pad(h[:, :, 2*c:3*c], ((0, 0), (2, 0), (0, 0)))[:, :S, :]
        g3 = _pad(h[:, :, 3*c:   ], ((0, 0), (0, 2), (0, 0)))[:, 2:, :]
        hs = torch.concatenate([g0, g1, g2, g3], axis=-1) @ w2
        x1 = x + hs
        h2 = _gelu(_layernorm(x1, axis=-1) @ w3) @ w4
        return x1 + h2

    x = A_q
    xn = _layernorm(x, axis=-1)
    return x + _A_ref(xn, A_k, A_v, A_shift_k, A_ssm_k, A_ssm_D) + _B_ref(xn, B_w1, B_w2, B_w3, B_w4)
```

```asm
; @launch grid=(256,1,1) block=(256,1,1) lds=163840
.amdgcn_target "amdgcn-amd-amdhsa--gfx950"
.text
.globl parallel_sum__ssm_conv_h3__mixer_s_mlp__prompt_kernel
.p2align 8
.type parallel_sum__ssm_conv_h3__mixer_s_mlp__prompt_kernel,@function
parallel_sum__ssm_conv_h3__mixer_s_mlp__prompt_kernel:
    s_load_dwordx2 s[4:5], s[0:1], 0
    s_load_dwordx2 s[48:49], s[0:1], 104
    s_getpc_b64 s[56:57]
L_pc:
    v_lshrrev_b32 v1, 5, v0
    s_and_b32 s58, s2, 0xf8
    v_add_lshl_u32 v1, s58, v1, 7
    v_min_u32 v1, L_exit-L_pc, v1
    global_load_dword v1, v1, s[56:57]
    s_cmp_ge_u32 s2, 256
    s_cbranch_scc1 L_exit
    s_load_dwordx2 s[28:29], s[0:1], 56
    s_load_dwordx2 s[8:9], s[0:1], 8
    s_load_dwordx2 s[12:13], s[0:1], 16
    s_load_dwordx2 s[16:17], s[0:1], 24
    s_load_dwordx2 s[20:21], s[0:1], 32
    s_load_dwordx2 s[24:25], s[0:1], 40
    s_load_dwordx2 s[32:33], s[0:1], 64
    s_load_dwordx2 s[44:45], s[0:1], 88
    v_lshrrev_b32 v2, 6, v0
    s_lshr_b32 s56, s2, 3
    v_readfirstlane_b32 s52, v2
    s_cmp_ge_u32 s56, 28
    s_cbranch_scc1 L_spare
    v_and_b32 v0, 63, v0
    s_mul_i32 s57, s56, 37
    s_lshr_b32 s57, s57, 8
    s_mul_i32 s58, s57, 7
    s_sub_u32 s53, s56, s58
    s_and_b32 s58, s2, 7
    s_lshl_b32 s58, s58, 2
    s_add_u32 s54, s58, s57
    v_lshrrev_b32 v62, 3, v0
    v_and_b32 v63, 7, v0
    s_mul_i32 s3, s54, 57344
    s_sub_u32 s59, 1836800, s3
    s_min_u32 s6, s59, 60928
    s_mov_b32 s7, 0x20000
    s_mul_i32 s27, s52, 119
    v_add_u32 v2, s27, v62
    s_lshl_b32 s60, s53, 2
    s_lshr_b32 s60, 50479408, s60
    s_and_b32 s60, s60, 7
    v_bfe_u32 v3, v2, 1, 3
    v_xor_b32 v3, v3, v63
    s_cmp_eq_u32 s54, 0
    s_cselect_b32 s60, 0, s60
    s_mul_i32 s62, s60, 3072
    v_lshlrev_b32 v2, 7, v2
    s_and_b32 s60, s60, 1
    s_lshl_b32 s60, s60, 6
    v_lshl_add_u32 v68, v3, 4, v2
    v_xor_b32 v64, s60, v68
    v_xor_b32 v65, 64, v64
    s_or_b32 s36, s54, s52
    s_cmp_eq_u32 s36, 0
    s_cselect_b32 s36, 64, 0
    v_mov_b32 v4, 0x80000000
    v_cmp_gt_u32 vcc, s36, v0
    s_min_u32 s60, s36, 48
    s_lshl_b32 s27, s27, 7
    v_cndmask_b32 v66, v64, v4, vcc
    v_cmp_gt_u32 vcc, s60, v0
    s_sub_u32 s61, s3, 1792
    s_ashr_i32 s59, s61, 31
    v_cndmask_b32 v67, v65, v4, vcc
    s_add_u32 m0, s27, s62
    s_waitcnt lgkmcnt(0)
    s_add_u32 s4, s4, s61
    s_addc_u32 s5, s5, s59
    buffer_load_dwordx4 v66, s[4:7], s62 offen offset:0  lds
    s_lshl_b32 s37, s53, 5
    s_add_u32 s37, s37, s54
    s_lshl_b32 s57, s37, 2
    v_mov_b32 v84, s57
    s_lshl_b32 s57, s54, 3
    s_sub_u32 s57, s57, 1
    v_min_u32 v19, 4, v0
    v_add_lshl_u32 v19, s57, v19, 7
    s_lshl_b32 s60, s52, 2
    v_and_b32 v110, 3, v0
    v_add_u32 v110, s60, v110
    v_min_u32 v110, 13, v110
    s_mul_i32 s60, s54, 12544
    s_lshl_b32 s61, s53, 7
    s_add_u32 s60, s60, s61
    v_mul_u32_u24 v110, 896, v110
    v_add_u32 v110, s60, v110
    global_load_dword v111, v110, s[28:29]
    global_load_dword v112, v110, s[32:33]
    s_mov_b32 s57, 126976
    v_writelane_b32 v19, s57, 0
    v_and_b32 v2, 2, v62
    s_and_b32 s56, s52, 1
    s_lshl_b32 s56, s56, 2
    v_xor_b32 v2, v2, v63
    v_xor_b32 v2, s56, v2
    v_mul_u32_u24 v3, 896, v62
    v_lshl_add_u32 v69, v2, 4, v3
    buffer_load_dwordx4 v67, s[4:7], s62 offen offset:1024  lds
    s_lshl_b32 s39, s52, 10
    s_lshl_b32 s40, s53, 7
    s_mul_i32 s38, s52, 7168
    s_lshr_b32 s56, s36, 1
    v_cmp_gt_u32 vcc, s56, v0
    s_add_u32 s3, s3, s40
    s_sub_u32 s56, s3, 3584
    s_ashr_i32 s57, s56, 31
    buffer_load_dwordx4 v64, s[4:7], s62 offen offset:2048  lds
    v_cndmask_b32 v71, v69, v4, vcc
    s_add_u32 s8, s8, s56
    s_addc_u32 s9, s9, s57
    s_mov_b32 s10, 60928
    s_mov_b32 s11, 0x20000
    s_mov_b32 s14, 1835008
    s_mov_b32 s15, 0x20000
    s_mov_b32 s18, 3584
    s_mov_b32 s19, 0x20000
    s_add_u32 s62, s62, 3072
    s_cmp_eq_u32 s62, 15360
    s_cselect_b32 s62, 0, s62
    s_lshr_b32 s63, s62, 4
    s_and_b32 s63, s63, 64
    v_xor_b32 v64, s63, v68
    v_xor_b32 v65, 64, v64
    s_add_u32 m0, s27, s62
    s_nop 0
    buffer_load_dwordx4 v64, s[4:7], s62 offen offset:0  lds
    s_mov_b32 s50, 18837504
    s_mov_b32 s51, 0x20000
    s_and_b32 s56, s52, 1
    s_lshl_b32 s56, s56, 3
    v_and_b32 v72, 31, v0
    v_xor_b32 v72, s56, v72
    v_lshrrev_b32 v2, 5, v0
    v_mul_u32_u24 v2, 896, v2
    buffer_load_dwordx4 v65, s[4:7], s62 offen offset:1024  lds
    v_lshl_add_u32 v72, v72, 2, v2
    s_lshl_b32 s41, s53, 2
    s_add_u32 s41, s41, s52
    v_and_b32 v75, 15, v0
    v_lshlrev_b32 v85, 3, v75
    v_add_u32 v70, s40, v69
    s_and_b32 s43, s54, 3
    s_lshl_b32 s43, s43, 2
    buffer_load_dwordx4 v64, s[4:7], s62 offen offset:2048  lds
    s_lshr_b32 s43, 0, s43
    s_and_b32 s43, s43, 15
    s_lshl_b32 s43, s43, 12
    s_add_u32 s43, s43, s39
    s_mov_b32 s30, 401408
    s_mov_b32 s31, 0x20000
    s_mov_b32 s34, 401408
    s_mov_b32 s35, 0x20000
    s_add_u32 s62, s62, 3072
    s_cmp_eq_u32 s62, 15360
    s_cselect_b32 s62, 0, s62
    s_lshr_b32 s63, s62, 4
    s_and_b32 s63, s63, 64
    v_xor_b32 v64, s63, v68
    v_xor_b32 v65, 64, v64
    s_add_u32 m0, s27, s62
    s_nop 0
    buffer_load_dwordx4 v64, s[4:7], s62 offen offset:0  lds
    s_mov_b32 s22, 4096
    s_mov_b32 s23, 0x20000
    s_mov_b32 s46, 1835008
    s_mov_b32 s47, 0x20000
    v_lshlrev_b32 v5, 4, v0
    v_lshlrev_b32 v22, 2, v0
    v_lshrrev_b32 v80, 4, v0
    v_lshrrev_b32 v81, 5, v0
    buffer_load_dwordx4 v65, s[4:7], s62 offen offset:1024  lds
    v_and_b32 v18, 31, v0
    v_lshlrev_b32 v18, 2, v18
    v_mov_b32 v76, 0x3f803f80
    v_mov_b32 v77, 0x3f803f80
    v_mov_b32 v78, 0x3f803f80
    v_mov_b32 v79, 0x3f803f80
    v_lshlrev_b32 v82, 1, v75
    v_subrev_u32 v2, 7, v82
    buffer_load_dwordx4 v64, s[4:7], s62 offen offset:2048  lds
    v_cmp_lt_u32 vcc, 3, v75
    v_subrev_u32 v3, 16, v82
    s_nop 0
    v_cndmask_b32 v82, v82, v2, vcc
    v_cmp_lt_u32 vcc, 11, v75
    s_nop 1
    v_cndmask_b32 v82, v82, v3, vcc
    s_mul_i32 s56, s52, 17
    v_add_u32 v91, s56, v82
    v_bfe_u32 v2, v91, 1, 3
    s_add_u32 s62, s62, 3072
    s_cmp_eq_u32 s62, 15360
    s_cselect_b32 s62, 0, s62
    s_lshr_b32 s63, s62, 4
    s_and_b32 s63, s63, 64
    v_xor_b32 v64, s63, v68
    v_xor_b32 v65, 64, v64
    s_add_u32 m0, s27, s62
    s_nop 0
    buffer_load_dwordx4 v64, s[4:7], s62 offen offset:0  lds
    v_xor_b32 v2, v2, v80
    v_mul_u32_u24 v3, 896, v91
    v_lshl_add_u32 v88, v2, 4, v3
    v_xor_b32 v89, 64, v88
    s_add_u32 s56, s56, 16
    s_mul_i32 s57, s56, 896
    v_add_u32 v90, s57, v5
    v_mov_b32 v2, s56
    v_cmp_eq_u32 vcc, 4, v0
    s_nop 1
    v_cndmask_b32 v91, v91, v2, vcc
    v_lshlrev_b32 v2, 2, v91
    v_add_u32 v92, 163488, v2
    v_lshlrev_b32 v91, 3, v91
    v_add_u32 v91, 162944, v91
    v_and_b32 v2, 3, v0
    v_cmp_eq_u32 s[66:67], 1, v2
    v_cmp_eq_u32 s[68:69], 2, v2
    v_cmp_eq_u32 s[70:71], 3, v2
    v_mul_u32_u24 v23, 4512, v2
    v_lshlrev_b32 v2, 3, v2
    v_lshrrev_b32 v3, 2, v75
    v_lshl_add_u32 v93, v3, 7, v2
    v_lshl_add_u32 v23, v3, 7, v23
    v_lshl_add_u32 v23, v80, 4, v23
    v_lshrrev_b32 v2, 3, v75
    v_and_b32 v3, 1, v80
    v_lshl_add_u32 v4, v3, 1, v2
    v_xor_b32 v4, s52, v4
    v_lshl_add_u32 v4, v4, 5, v93
    v_lshl_add_u32 v73, v80, 10, v4
    v_add_u32 v73, 61056, v73
    v_lshl_add_u32 v4, v2, 1, v3
    v_lshl_add_u32 v93, v4, 5, v93
    s_and_b32 s72, s52, 1
    s_lshr_b32 s73, s52, 1
    v_lshl_add_u32 v52, v81, 10, v93
    s_mul_i32 s56, s72, 4160
    v_xor_b32 v52, s56, v52
    v_add_u32 v52, 61056, v52
    v_xor_b32 v53, 64, v52
    s_mul_i32 s65, s52, 12288
    s_add_u32 s65, s65, 65536
    v_and_b32 v2, 2, v62
    v_lshlrev_b32 v2, 1, v2
    v_xor_b32 v2, v2, v63
    v_mul_u32_u24 v3, 896, v62
    v_lshl_add_u32 v74, v2, 4, v3
    s_mul_i32 s56, s41, 37
    s_lshr_b32 s56, s56, 8
    s_lshl_b32 s56, s56, 2
    s_lshr_b32 s56, 0x4031, s56
    s_and_b32 s56, s56, 15
    v_add_u32 v94, s56, v82
    v_mul_u32_u24 v2, 7, v94
    v_bfe_u32 v3, v2, 1, 3
    v_xor_b32 v3, v3, v80
    v_lshlrev_b32 v3, 4, v3
    v_lshl_add_u32 v242, v2, 7, v3
    v_xor_b32 v243, 64, v242
    v_add_u32 v2, 1, v2
    v_bfe_u32 v3, v2, 1, 3
    v_xor_b32 v3, v3, v80
    v_lshlrev_b32 v3, 4, v3
    v_lshl_add_u32 v244, v2, 7, v3
    v_xor_b32 v245, 64, v244
    v_add_u32 v2, 1, v2
    v_bfe_u32 v3, v2, 1, 3
    v_xor_b32 v3, v3, v80
    v_lshlrev_b32 v3, 4, v3
    v_lshl_add_u32 v246, v2, 7, v3
    v_xor_b32 v247, 64, v246
    v_add_u32 v2, 1, v2
    v_bfe_u32 v3, v2, 1, 3
    v_xor_b32 v3, v3, v80
    v_lshlrev_b32 v3, 4, v3
    v_lshl_add_u32 v248, v2, 7, v3
    v_xor_b32 v249, 64, v248
    v_add_u32 v2, 1, v2
    v_bfe_u32 v3, v2, 1, 3
    v_xor_b32 v3, v3, v80
    v_lshlrev_b32 v3, 4, v3
    buffer_load_dwordx4 v65, s[4:7], s62 offen offset:1024  lds
    v_lshl_add_u32 v250, v2, 7, v3
    v_xor_b32 v251, 64, v250
    v_add_u32 v2, 1, v2
    v_bfe_u32 v3, v2, 1, 3
    v_xor_b32 v3, v3, v80
    v_lshlrev_b32 v3, 4, v3
    buffer_load_dwordx4 v64, s[4:7], s62 offen offset:2048  lds
    v_lshl_add_u32 v252, v2, 7, v3
    v_xor_b32 v253, 64, v252
    v_add_u32 v2, 1, v2
    v_bfe_u32 v3, v2, 1, 3
    v_xor_b32 v3, v3, v80
    v_lshlrev_b32 v3, 4, v3
    s_add_u32 s62, s62, 3072
    s_cmp_eq_u32 s62, 15360
    s_cselect_b32 s62, 0, s62
    s_lshr_b32 s63, s62, 4
    s_and_b32 s63, s63, 64
    v_xor_b32 v64, s63, v68
    v_xor_b32 v65, 64, v64
    s_add_u32 m0, s27, s62
    s_nop 0
    buffer_load_dwordx4 v64, s[4:7], s62 offen offset:0  lds
    v_lshl_add_u32 v254, v2, 7, v3
    v_xor_b32 v255, 64, v254
    v_lshlrev_b32 v94, 3, v94
    v_add_u32 v94, 162944, v94
    v_and_b32 v2, 16, v0
    v_add_u32 v83, v2, v82
    buffer_load_dwordx4 v65, s[4:7], s62 offen offset:1024  lds
    v_add_u32 v2, 2, v83
    v_lshlrev_b32 v104, 3, v2
    v_add_u32 v104, 162944, v104
    v_lshlrev_b32 v105, 2, v2
    v_add_u32 v105, 163488, v105
    v_mul_u32_u24 v2, 7, v2
    buffer_load_dwordx4 v64, s[4:7], s62 offen offset:2048  lds
    v_add_u32 v2, s53, v2
    v_bfe_u32 v3, v2, 1, 3
    v_lshlrev_b32 v3, 4, v3
    v_lshl_add_u32 v2, v2, 7, v3
    v_lshl_add_u32 v2, v81, 3, v2
    s_lshl_b32 s56, s52, 5
    s_add_u32 m0, s43, 61056
    s_mul_i32 s42, s43, 7
    buffer_load_dwordx4 v70, s[28:31], s42 offen lds
    v_xor_b32 v102, s56, v2
    v_xor_b32 v103, 16, v102
    s_mul_i32 s57, s73, 28672
    s_lshl_b32 s56, s73, 8
    s_lshl_b32 s58, s72, 6
    v_add_u32 v100, s56, v104
    s_add_u32 s43, s43, 4096
    s_sub_u32 s42, s43, 57344
    s_cselect_b32 s43, s43, s42
    s_add_u32 m0, s43, 61056
    s_mul_i32 s42, s43, 7
    buffer_load_dwordx4 v70, s[28:31], s42 offen lds
    s_lshl_b32 s56, s73, 7
    v_add_u32 v101, s56, v105
    v_xor_b32 v2, s58, v2
    v_add_u32 v96, s57, v2
    v_xor_b32 v97, 16, v96
    v_xor_b32 v98, 32, v96
    s_add_u32 s43, s43, 4096
    s_sub_u32 s42, s43, 57344
    s_cselect_b32 s43, s43, s42
    s_add_u32 m0, s43, 61056
    s_mul_i32 s42, s43, 7
    buffer_load_dwordx4 v70, s[28:31], s42 offen lds
    v_xor_b32 v99, 48, v96
    v_mul_u32_u24 v20, 896, v83
    v_lshl_add_u32 v20, v81, 4, v20
    v_lshlrev_b32 v21, 14, v81
    v_lshl_add_u32 v21, v83, 2, v21
    s_mul_i32 s56, s73, 18048
    s_add_u32 s43, s43, 4096
    s_sub_u32 s42, s43, 57344
    s_cselect_b32 s43, s43, s42
    s_add_u32 m0, s43, 61056
    s_mul_i32 s42, s43, 7
    buffer_load_dwordx4 v70, s[28:31], s42 offen lds
    s_lshl_b32 s57, s72, 8
    s_add_u32 s58, s56, s57
    s_add_u32 s58, s58, 118400
    v_add_u32 v23, s58, v23
    s_lshl_b32 s58, s72, 11
    s_add_u32 s56, s56, s58
    s_add_u32 s43, s43, 4096
    s_sub_u32 s42, s43, 57344
    s_cselect_b32 s43, s43, s42
    s_add_u32 m0, s43, 61056
    s_mul_i32 s42, s43, 7
    buffer_load_dwordx4 v70, s[28:31], s42 offen lds
    s_add_u32 s56, s56, 118784
    v_add_u32 v25, s56, v5
    s_sub_u32 s58, s58, 8
    v_and_b32 v40, 4, v22
    v_add_u32 v40, s58, v40
    s_mul_i32 s56, s73, 4224
    s_add_u32 s43, s43, 4096
    s_sub_u32 s42, s43, 57344
    s_cselect_b32 s43, s43, s42
    s_add_u32 m0, s43, 61056
    s_mul_i32 s42, s43, 7
    buffer_load_dwordx4 v70, s[28:31], s42 offen lds
    s_add_u32 s56, s56, s57
    s_add_u32 s56, s56, 154616
    v_lshlrev_b32 v2, 4, v80
    v_sub_u32 v3, v2, v85
    v_add_u32 v24, s56, v3
    v_sub_u32 v3, 7, v80
    s_add_u32 s43, s43, 4096
    s_sub_u32 s42, s43, 57344
    s_cselect_b32 s43, s43, s42
    s_add_u32 m0, s43, 61056
    s_mul_i32 s42, s43, 7
    buffer_load_dwordx4 v70, s[28:31], s42 offen lds
    v_xor_b32 v3, v3, v63
    v_lshlrev_b32 v3, 4, v3
    v_lshl_add_u32 v3, v75, 7, v3
    s_lshl_b32 s56, s52, 11
    s_add_u32 s56, s56, 138880
    v_add_u32 v106, s56, v3
    s_add_u32 s43, s43, 4096
    s_sub_u32 s42, s43, 57344
    s_cselect_b32 s43, s43, s42
    s_add_u32 m0, s43, 61056
    s_mul_i32 s42, s43, 7
    buffer_load_dwordx4 v70, s[28:31], s42 offen lds
    v_xor_b32 v107, 64, v106
    v_add_u32 v95, s56, v5
    v_xor_b32 v3, v62, v63
    v_lshlrev_b32 v3, 4, v3
    v_lshl_add_u32 v41, v62, 12, v3
    s_mul_i32 s56, s52, 9024
    s_add_u32 s43, s43, 4096
    s_sub_u32 s42, s43, 57344
    s_cselect_b32 s43, s43, s42
    s_add_u32 m0, s43, 61056
    s_mul_i32 s42, s43, 7
    buffer_load_dwordx4 v70, s[28:31], s42 offen lds
    s_add_u32 s56, s56, 118400
    v_mul_u32_u24 v3, 4512, v81
    v_add_u32 v3, s56, v3
    v_min_u32 v38, 92, v18
    v_lshl_add_u32 v38, v38, 2, v3
    v_mul_u32_u24 v39, 4224, v81
    s_add_u32 s43, s43, 4096
    s_sub_u32 s42, s43, 57344
    s_cselect_b32 s43, s43, s42
    s_add_u32 m0, s43, 61056
    s_mul_i32 s42, s43, 7
    buffer_load_dwordx4 v70, s[28:31], s42 offen lds
    v_lshl_add_u32 v39, v63, 4, v39
    v_add_u32 v39, 158592, v39
    s_lshl_b32 s74, s54, 10
    s_lshl_b32 s56, s41, 2
    s_add_u32 s75, s74, s56
    s_lshl_b32 s76, s41, 12
    s_add_u32 s43, s43, 4096
    s_sub_u32 s42, s43, 57344
    s_cselect_b32 s43, s43, s42
    s_add_u32 m0, s43, 61056
    s_mul_i32 s42, s43, 7
    buffer_load_dwordx4 v70, s[28:31], s42 offen lds
    s_lshl_b32 s56, s54, 7
    s_add_u32 s76, s76, s56
    s_lshl_b32 s77, s53, 2
    s_lshr_b32 s56, s54, 3
    s_add_u32 s77, s77, s56
    s_lshl_b32 s77, s77, 12
    s_add_u32 s43, s43, 4096
    s_sub_u32 s42, s43, 57344
    s_cselect_b32 s43, s43, s42
    s_add_u32 m0, s43, 61056
    s_mul_i32 s42, s43, 7
    buffer_load_dwordx4 v70, s[28:31], s42 offen lds
    v_mov_b32 v108, 0xbdd2d3e8
    v_mov_b32 v109, 0xbdd2d3e8
    s_lshl_b32 s37, s37, 13
    s_lshl_b32 s57, s73, 12
    s_add_u32 s57, s57, s37
    s_add_u32 s20, s20, s57
    s_addc_u32 s21, s21, 0
    s_add_u32 s43, s43, 4096
    s_sub_u32 s42, s43, 57344
    s_cselect_b32 s43, s43, s42
    s_add_u32 m0, s43, 61056
    s_mul_i32 s42, s43, 7
    buffer_load_dwordx4 v70, s[28:31], s42 offen lds
    s_lshl_b32 s57, s52, 11
    s_add_u32 s37, s37, s57
    s_mul_i32 s78, s54, 57344
    s_mul_i32 s79, s54, 229376
    s_lshl_b32 s57, s52, 12
    s_add_u32 s79, s79, s57
    s_add_u32 s43, s43, 4096
    s_sub_u32 s42, s43, 57344
    s_cselect_b32 s43, s43, s42
    s_add_u32 m0, s43, 61056
    s_mul_i32 s42, s43, 7
    buffer_load_dwordx4 v70, s[28:31], s42 offen lds
    s_add_u32 s79, s79, 7995392
    s_mov_b32 s82, 0xc0135761
    s_mov_b32 s83, 0xc0135761
    s_mul_i32 s80, s41, 115712
    s_add_u32 s80, s80, 15335424
    s_lshl_b32 s81, s41, 11
    s_waitcnt vmcnt(14)
    ds_read_b128 v[62:65], v90 offset:0
    ds_read_b128 v[186:189], v88 offset:0
    ds_read_b128 v[190:193], v89 offset:0
    ds_read_b128 v[194:197], v88 offset:128
    ds_read_b128 v[198:201], v89 offset:128
    ds_read_b128 v[202:205], v88 offset:256
    ds_read_b128 v[206:209], v89 offset:256
    ds_read_b128 v[210:213], v88 offset:384
    ds_read_b128 v[214:217], v89 offset:384
    ds_read_b128 v[218:221], v88 offset:512
    ds_read_b128 v[222:225], v89 offset:512
    ds_read_b128 v[226:229], v88 offset:640
    ds_read_b128 v[230:233], v89 offset:640
    ds_read_b128 v[234:237], v88 offset:768
    ds_read_b128 v[238:241], v89 offset:768
    s_waitcnt lgkmcnt(14)
    v_dot2_f32_bf16 v1, v62, v76, 0
    v_dot2_f32_bf16 v66, v62, v62, 0
    v_dot2_f32_bf16 v1, v63, v76, v1
    v_dot2_f32_bf16 v66, v63, v63, v66
    v_dot2_f32_bf16 v1, v64, v76, v1
    v_dot2_f32_bf16 v66, v64, v64, v66
    v_dot2_f32_bf16 v1, v65, v76, v1
    v_dot2_f32_bf16 v66, v65, v65, v66
    s_waitcnt lgkmcnt(13)
    v_mfma_f32_16x16x32_bf16 v[110:113], v[186:189], v[186:189], 0
    v_mfma_f32_16x16x32_bf16 v[80:83], v[76:79], v[186:189], 0
    v_cmp_gt_u32 vcc, 56, v0
    s_waitcnt lgkmcnt(12)
    v_mfma_f32_16x16x32_bf16 v[110:113], v[190:193], v[190:193], v[110:113]
    v_cndmask_b32 v1, 0, v1, vcc
    v_mfma_f32_16x16x32_bf16 v[80:83], v[76:79], v[190:193], v[80:83]
    v_cndmask_b32 v66, 0, v66, vcc
    s_waitcnt lgkmcnt(11)
    v_mfma_f32_16x16x32_bf16 v[110:113], v[194:197], v[194:197], v[110:113]
    v_add_f32_dpp v1, v1, v1 row_ror:8 row_mask:0xf bank_mask:0xf
    v_mfma_f32_16x16x32_bf16 v[80:83], v[76:79], v[194:197], v[80:83]
    v_add_f32_dpp v66, v66, v66 row_ror:8 row_mask:0xf bank_mask:0xf
    s_waitcnt lgkmcnt(10)
    v_mfma_f32_16x16x32_bf16 v[110:113], v[198:201], v[198:201], v[110:113]
    v_add_f32_dpp v1, v1, v1 row_ror:4 row_mask:0xf bank_mask:0xf
    v_mfma_f32_16x16x32_bf16 v[80:83], v[76:79], v[198:201], v[80:83]
    s_waitcnt lgkmcnt(9)
    v_mfma_f32_16x16x32_bf16 v[110:113], v[202:205], v[202:205], v[110:113]
    v_add_f32_dpp v66, v66, v66 row_ror:4 row_mask:0xf bank_mask:0xf
    v_mfma_f32_16x16x32_bf16 v[80:83], v[76:79], v[202:205], v[80:83]
    v_add_f32_dpp v1, v1, v1 row_ror:2 row_mask:0xf bank_mask:0xf
    s_waitcnt lgkmcnt(8)
    v_mfma_f32_16x16x32_bf16 v[110:113], v[206:209], v[206:209], v[110:113]
    v_add_f32_dpp v66, v66, v66 row_ror:2 row_mask:0xf bank_mask:0xf
    v_mfma_f32_16x16x32_bf16 v[80:83], v[76:79], v[206:209], v[80:83]
    v_add_f32_dpp v1, v1, v1 row_ror:1 row_mask:0xf bank_mask:0xf
    s_waitcnt lgkmcnt(7)
    v_mfma_f32_16x16x32_bf16 v[110:113], v[210:213], v[210:213], v[110:113]
    v_add_f32_dpp v66, v66, v66 row_ror:1 row_mask:0xf bank_mask:0xf
    v_mfma_f32_16x16x32_bf16 v[80:83], v[76:79], v[210:213], v[80:83]
    v_mov_b32 v2, v1
    s_waitcnt lgkmcnt(6)
    v_mfma_f32_16x16x32_bf16 v[110:113], v[214:217], v[214:217], v[110:113]
    v_mfma_f32_16x16x32_bf16 v[80:83], v[76:79], v[214:217], v[80:83]
    v_mov_b32 v3, v66
    s_waitcnt lgkmcnt(5)
    v_mfma_f32_16x16x32_bf16 v[110:113], v[218:221], v[218:221], v[110:113]
    v_permlane16_swap_b32 v2, v1
    v_mfma_f32_16x16x32_bf16 v[80:83], v[76:79], v[218:221], v[80:83]
    v_permlane16_swap_b32 v3, v66
    s_waitcnt lgkmcnt(4)
    v_mfma_f32_16x16x32_bf16 v[110:113], v[222:225], v[222:225], v[110:113]
    v_add_f32 v1, v1, v2
    v_mfma_f32_16x16x32_bf16 v[80:83], v[76:79], v[222:225], v[80:83]
    v_add_f32 v66, v66, v3
    s_waitcnt lgkmcnt(3)
    v_mfma_f32_16x16x32_bf16 v[110:113], v[226:229], v[226:229], v[110:113]
    v_mov_b32 v2, v1
    v_mfma_f32_16x16x32_bf16 v[80:83], v[76:79], v[226:229], v[80:83]
    s_waitcnt lgkmcnt(2)
    v_mfma_f32_16x16x32_bf16 v[110:113], v[230:233], v[230:233], v[110:113]
    v_mov_b32 v3, v66
    v_mfma_f32_16x16x32_bf16 v[80:83], v[76:79], v[230:233], v[80:83]
    v_permlane32_swap_b32 v2, v1
    s_waitcnt lgkmcnt(1)
    v_mfma_f32_16x16x32_bf16 v[110:113], v[234:237], v[234:237], v[110:113]
    v_permlane32_swap_b32 v3, v66
    v_mfma_f32_16x16x32_bf16 v[80:83], v[76:79], v[234:237], v[80:83]
    v_add_f32 v1, v1, v2
    s_waitcnt lgkmcnt(0)
    v_mfma_f32_16x16x32_bf16 v[110:113], v[238:241], v[238:241], v[110:113]
    v_add_f32 v66, v66, v3
    v_mfma_f32_16x16x32_bf16 v[80:83], v[76:79], v[238:241], v[80:83]
    v_cmp_eq_u32 vcc, 4, v0
    s_barrier
    s_nop 3
    v_cndmask_b32 v110, v110, v111, s[66:67]
    buffer_load_dword v19, v19, s[48:51], 0 offen sc1
    v_cndmask_b32 v110, v110, v112, s[68:69]
    global_load_dword v84, v84, s[24:25]
    v_cndmask_b32 v110, v110, v113, s[70:71]
    s_add_u32 m0, s39, 118400
    s_mov_b32 s64, s38
    buffer_load_dwordx4 v71, s[8:11], s64 offen  lds
    v_cndmask_b32 v80, v80, v1, vcc
    s_add_u32 m0, s39, 122496
    s_add_u32 s64, s38, 28672
    buffer_load_dwordx4 v69, s[8:11], s64 offen  lds
    v_cndmask_b32 v110, v110, v66, vcc
    s_add_u32 m0, s39, 127616
    s_add_u32 s64, s38, s3
    buffer_load_dwordx4 v69, s[12:15], s64 offen  lds
    v_mul_f32 v62, 0x3b124925, v80
    v_mul_f32 v2, 0x3b124925, v110
    v_fma_f32 v2, -v62, v62, v2
    v_max_f32 v2, 0, v2
    s_add_u32 m0, s39, 131712
    s_add_u32 s64, s64, 28672
    buffer_load_dwordx4 v69, s[12:15], s64 offen  lds
    v_add_f32 v3, 0x3727c5ac, v2
    v_rsq_f32 v65, v3
    s_nop 0
    v_mul_f32 v2, v2, v65
    v_mul_f32 v2, v2, v65
    v_add_f32 v2, 0x3727c5ac, v2
    v_rsq_f32 v2, v2
    s_mov_b32 exec_lo, 0x00f0001f
    s_mov_b32 exec_hi, 0xf0000f00
    v_mul_f32 v63, v2, v65
    ds_write_b32 v92, v65
    ds_write_b64 v91, v[62:63]
    s_mov_b64 exec, -1
    s_lshl_b32 s64, s72, 8
    s_add_u32 m0, s64, 126592
    s_mul_i32 s64, s64, 7
    s_add_u32 s64, s64, 57344
    buffer_load_dword v72, s[8:11], s64 offen  lds
    s_lshl_b32 s64, s41, 7
    buffer_load_dword v86, v85, s[16:19], s64 offen
    buffer_load_dword v87, v85, s[16:19], s64 offen offset:4
    s_lshl_b32 s62, s72, 11
    buffer_load_dwordx4 v[28:31], v5, s[20:23], s62 offen offset:0
    buffer_load_dwordx4 v[34:37], v5, s[20:23], s62 offen offset:1024
    s_waitcnt vmcnt(11)
    s_barrier
    ds_read_b64_tr_b16 v[186:187], v73 offset:0
    ds_read_b64_tr_b16 v[188:189], v73 offset:512
    ds_read_b64_tr_b16 v[190:191], v73 offset:4096
    ds_read_b64_tr_b16 v[192:193], v73 offset:4608
    ds_read_b64_tr_b16 v[194:195], v73 offset:8192
    ds_read_b64_tr_b16 v[196:197], v73 offset:8704
    ds_read_b64_tr_b16 v[198:199], v73 offset:12288
    ds_read_b64_tr_b16 v[200:201], v73 offset:12800
    ds_read_b64_tr_b16 v[202:203], v73 offset:16384
    ds_read_b64_tr_b16 v[204:205], v73 offset:16896
    ds_read_b64_tr_b16 v[206:207], v73 offset:20480
    ds_read_b64_tr_b16 v[208:209], v73 offset:20992
    ds_read_b64_tr_b16 v[210:211], v73 offset:24576
    ds_read_b64_tr_b16 v[212:213], v73 offset:25088
    ds_read_b64_tr_b16 v[214:215], v73 offset:28672
    ds_read_b64_tr_b16 v[216:217], v73 offset:29184
    s_waitcnt lgkmcnt(14)
    v_mfma_f32_16x16x32_bf16 v[62:65], v[186:189], v[76:79], 0
    ds_read_b64_tr_b16 v[218:219], v73 offset:32768
    ds_read_b64_tr_b16 v[220:221], v73 offset:33280
    s_waitcnt lgkmcnt(14)
    v_mfma_f32_16x16x32_bf16 v[62:65], v[190:193], v[76:79], v[62:65]
    ds_read_b64_tr_b16 v[222:223], v73 offset:36864
    ds_read_b64_tr_b16 v[224:225], v73 offset:37376
    s_waitcnt lgkmcnt(14)
    v_mfma_f32_16x16x32_bf16 v[62:65], v[194:197], v[76:79], v[62:65]
    ds_read_b64_tr_b16 v[226:227], v73 offset:40960
    ds_read_b64_tr_b16 v[228:229], v73 offset:41472
    s_waitcnt lgkmcnt(14)
    v_mfma_f32_16x16x32_bf16 v[62:65], v[198:201], v[76:79], v[62:65]
    ds_read_b64_tr_b16 v[230:231], v73 offset:45056
    ds_read_b64_tr_b16 v[232:233], v73 offset:45568
    s_waitcnt lgkmcnt(14)
    v_mfma_f32_16x16x32_bf16 v[62:65], v[202:205], v[76:79], v[62:65]
    ds_read_b64_tr_b16 v[234:235], v73 offset:49152
    ds_read_b64_tr_b16 v[236:237], v73 offset:49664
    s_waitcnt lgkmcnt(14)
    v_mfma_f32_16x16x32_bf16 v[62:65], v[206:209], v[76:79], v[62:65]
    ds_read_b64_tr_b16 v[238:239], v73 offset:53248
    ds_read_b64_tr_b16 v[240:241], v73 offset:53760
    s_waitcnt lgkmcnt(14)
    v_mfma_f32_16x16x32_bf16 v[62:65], v[210:213], v[76:79], v[62:65]
    ds_read_b128 v[138:141], v242 offset:0
    s_waitcnt lgkmcnt(13)
    v_mfma_f32_16x16x32_bf16 v[62:65], v[214:217], v[76:79], v[62:65]
    ds_read_b128 v[142:145], v242 offset:14336
    s_waitcnt lgkmcnt(12)
    v_mfma_f32_16x16x32_bf16 v[62:65], v[218:221], v[76:79], v[62:65]
    ds_read_b128 v[146:149], v242 offset:28672
    s_waitcnt lgkmcnt(11)
    v_mfma_f32_16x16x32_bf16 v[62:65], v[222:225], v[76:79], v[62:65]
    ds_read_b128 v[150:153], v242 offset:43008
    s_waitcnt lgkmcnt(10)
    v_mfma_f32_16x16x32_bf16 v[62:65], v[226:229], v[76:79], v[62:65]
    ds_read_b128 v[154:157], v243 offset:0
    s_waitcnt lgkmcnt(9)
    v_mfma_f32_16x16x32_bf16 v[62:65], v[230:233], v[76:79], v[62:65]
    ds_read_b128 v[158:161], v243 offset:14336
    s_waitcnt lgkmcnt(8)
    v_mfma_f32_16x16x32_bf16 v[62:65], v[234:237], v[76:79], v[62:65]
    ds_read_b128 v[162:165], v243 offset:28672
    s_waitcnt lgkmcnt(7)
    v_mfma_f32_16x16x32_bf16 v[62:65], v[238:241], v[76:79], v[62:65]
    s_barrier
    s_waitcnt lgkmcnt(5)
    v_mfma_f32_16x16x32_bf16 v[170:173], v[186:189], v[138:141], 0
    ds_read_b128 v[166:169], v243 offset:43008
    s_mul_i32 s27, s52, 14336
    s_mul_i32 s63, s27, 7
    s_add_u32 s63, s63, s40
    s_add_u32 m0, s27, 61056
    s_nop 0
    buffer_load_dwordx4 v74, s[32:35], s63 offen offset:0 lds
    v_mfma_f32_16x16x32_bf16 v[174:177], v[186:189], v[142:145], 0
    ds_read_b128 v[138:141], v244 offset:0
    s_add_u32 s63, s63, 6144
    buffer_load_dwordx4 v74, s[32:35], s63 offen offset:1024 lds
    s_waitcnt lgkmcnt(5)
    v_mfma_f32_16x16x32_bf16 v[178:181], v[186:189], v[146:149], 0
    ds_read_b128 v[142:145], v244 offset:14336
    s_add_u32 s63, s63, 6144
    buffer_load_dwordx4 v74, s[32:35], s63 offen offset:2048 lds
    v_mfma_f32_16x16x32_bf16 v[182:185], v[186:189], v[150:153], 0
    ds_read_b128 v[146:149], v244 offset:28672
    s_waitcnt lgkmcnt(5)
    v_mfma_f32_16x16x32_bf16 v[170:173], v[190:193], v[154:157], v[170:173]
    ds_read_b128 v[150:153], v244 offset:43008
    v_mfma_f32_16x16x32_bf16 v[174:177], v[190:193], v[158:161], v[174:177]
    ds_read_b128 v[154:157], v245 offset:0
    s_waitcnt lgkmcnt(5)
    v_mfma_f32_16x16x32_bf16 v[178:181], v[190:193], v[162:165], v[178:181]
    ds_read_b128 v[158:161], v245 offset:14336
    v_mfma_f32_16x16x32_bf16 v[182:185], v[190:193], v[166:169], v[182:185]
    ds_read_b128 v[162:165], v245 offset:28672
    s_waitcnt lgkmcnt(5)
    v_mfma_f32_16x16x32_bf16 v[170:173], v[194:197], v[138:141], v[170:173]
    ds_read_b128 v[166:169], v245 offset:43008
    v_mfma_f32_16x16x32_bf16 v[174:177], v[194:197], v[142:145], v[174:177]
    ds_read_b128 v[138:141], v246 offset:0
    s_waitcnt lgkmcnt(5)
    v_mfma_f32_16x16x32_bf16 v[178:181], v[194:197], v[146:149], v[178:181]
    ds_read_b128 v[142:145], v246 offset:14336
    v_mfma_f32_16x16x32_bf16 v[182:185], v[194:197], v[150:153], v[182:185]
    ds_read_b128 v[146:149], v246 offset:28672
    s_waitcnt lgkmcnt(5)
    v_mfma_f32_16x16x32_bf16 v[170:173], v[198:201], v[154:157], v[170:173]
    ds_read_b128 v[150:153], v246 offset:43008
    v_mfma_f32_16x16x32_bf16 v[174:177], v[198:201], v[158:161], v[174:177]
    ds_read_b128 v[154:157], v247 offset:0
    s_waitcnt lgkmcnt(5)
    v_mfma_f32_16x16x32_bf16 v[178:181], v[198:201], v[162:165], v[178:181]
    ds_read_b128 v[158:161], v247 offset:14336
    v_mfma_f32_16x16x32_bf16 v[182:185], v[198:201], v[166:169], v[182:185]
    ds_read_b128 v[162:165], v247 offset:28672
    s_waitcnt lgkmcnt(5)
    v_mfma_f32_16x16x32_bf16 v[170:173], v[202:205], v[138:141], v[170:173]
    ds_read_b128 v[166:169], v247 offset:43008
    v_mfma_f32_16x16x32_bf16 v[174:177], v[202:205], v[142:145], v[174:177]
    ds_read_b128 v[138:141], v248 offset:0
    s_waitcnt lgkmcnt(5)
    v_mfma_f32_16x16x32_bf16 v[178:181], v[202:205], v[146:149], v[178:181]
    ds_read_b128 v[142:145], v248 offset:14336
    v_mfma_f32_16x16x32_bf16 v[182:185], v[202:205], v[150:153], v[182:185]
    ds_read_b128 v[146:149], v248 offset:28672
    s_waitcnt lgkmcnt(5)
    v_mfma_f32_16x16x32_bf16 v[170:173], v[206:209], v[154:157], v[170:173]
    ds_read_b128 v[150:153], v248 offset:43008
    v_mfma_f32_16x16x32_bf16 v[174:177], v[206:209], v[158:161], v[174:177]
    ds_read_b128 v[154:157], v249 offset:0
    s_waitcnt lgkmcnt(5)
    v_mfma_f32_16x16x32_bf16 v[178:181], v[206:209], v[162:165], v[178:181]
    ds_read_b128 v[158:161], v249 offset:14336
    v_mfma_f32_16x16x32_bf16 v[182:185], v[206:209], v[166:169], v[182:185]
    ds_read_b128 v[162:165], v249 offset:28672
    s_waitcnt lgkmcnt(5)
    v_mfma_f32_16x16x32_bf16 v[170:173], v[210:213], v[138:141], v[170:173]
    ds_read_b128 v[166:169], v249 offset:43008
    v_mfma_f32_16x16x32_bf16 v[174:177], v[210:213], v[142:145], v[174:177]
    ds_read_b128 v[138:141], v250 offset:0
    s_waitcnt lgkmcnt(5)
    v_mfma_f32_16x16x32_bf16 v[178:181], v[210:213], v[146:149], v[178:181]
    ds_read_b128 v[142:145], v250 offset:14336
    v_mfma_f32_16x16x32_bf16 v[182:185], v[210:213], v[150:153], v[182:185]
    ds_read_b128 v[146:149], v250 offset:28672
    s_waitcnt lgkmcnt(5)
    v_mfma_f32_16x16x32_bf16 v[170:173], v[214:217], v[154:157], v[170:173]
    ds_read_b128 v[150:153], v250 offset:43008
    v_mfma_f32_16x16x32_bf16 v[174:177], v[214:217], v[158:161], v[174:177]
    ds_read_b128 v[154:157], v251 offset:0
    s_waitcnt lgkmcnt(5)
    v_mfma_f32_16x16x32_bf16 v[178:181], v[214:217], v[162:165], v[178:181]
    ds_read_b128 v[158:161], v251 offset:14336
    v_mfma_f32_16x16x32_bf16 v[182:185], v[214:217], v[166:169], v[182:185]
    ds_read_b128 v[162:165], v251 offset:28672
    s_add_u32 s63, s63, 6144
    buffer_load_dwordx4 v74, s[32:35], s63 offen offset:3072 lds
    s_waitcnt vmcnt(14)
    v_readfirstlane_b32 s55, v19
    s_waitcnt vmcnt(13)
    v_readfirstlane_b32 s26, v84
    s_getreg_b32 s36, hwreg(HW_REG_XCC_ID, 0, 4)
    s_mul_i32 s55, s55, 0x9e3779b1
    s_add_u32 s55, s55, 0x7f4a7c15
    s_add_u32 s36, s36, s55
    s_add_u32 s36, s36, 1
    v_mov_b32 v19, s55
    v_mov_b32 v4, s36
    s_add_u32 s61, s74, s40
    s_add_u32 s61, s61, 32768
    s_cmp_eq_u32 s52, 0
    s_cselect_b32 s61, s61, 0x7ffff000
    buffer_store_dword v4, v18, s[48:51], s61 offen sc1
    s_waitcnt lgkmcnt(5)
    v_mfma_f32_16x16x32_bf16 v[170:173], v[218:221], v[138:141], v[170:173]
    ds_read_b128 v[166:169], v251 offset:43008
    v_mfma_f32_16x16x32_bf16 v[174:177], v[218:221], v[142:145], v[174:177]
    ds_read_b128 v[138:141], v252 offset:0
    s_waitcnt lgkmcnt(5)
    v_mfma_f32_16x16x32_bf16 v[178:181], v[218:221], v[146:149], v[178:181]
    ds_read_b128 v[142:145], v252 offset:14336
    v_mfma_f32_16x16x32_bf16 v[182:185], v[218:221], v[150:153], v[182:185]
    ds_read_b128 v[146:149], v252 offset:28672
    s_waitcnt lgkmcnt(5)
    v_mfma_f32_16x16x32_bf16 v[170:173], v[222:225], v[154:157], v[170:173]
    ds_read_b128 v[150:153], v252 offset:43008
    v_mfma_f32_16x16x32_bf16 v[174:177], v[222:225], v[158:161], v[174:177]
    ds_read_b128 v[154:157], v253 offset:0
    s_waitcnt lgkmcnt(5)
    v_mfma_f32_16x16x32_bf16 v[178:181], v[222:225], v[162:165], v[178:181]
    ds_read_b128 v[158:161], v253 offset:14336
    v_mfma_f32_16x16x32_bf16 v[182:185], v[222:225], v[166:169], v[182:185]
    ds_read_b128 v[162:165], v253 offset:28672
    s_waitcnt lgkmcnt(5)
    v_mfma_f32_16x16x32_bf16 v[170:173], v[226:229], v[138:141], v[170:173]
    ds_read_b128 v[166:169], v253 offset:43008
    v_mfma_f32_16x16x32_bf16 v[174:177], v[226:229], v[142:145], v[174:177]
    ds_read_b128 v[138:141], v254 offset:0
    s_add_u32 m0, s27, 65152
    s_add_u32 s63, s63, 10240
    buffer_load_dwordx4 v74, s[32:35], s63 offen offset:0 lds
    s_waitcnt lgkmcnt(5)
    v_mfma_f32_16x16x32_bf16 v[178:181], v[226:229], v[146:149], v[178:181]
    ds_read_b128 v[142:145], v254 offset:14336
    v_mfma_f32_16x16x32_bf16 v[182:185], v[226:229], v[150:153], v[182:185]
    ds_read_b128 v[146:149], v254 offset:28672
    s_waitcnt lgkmcnt(5)
    v_mfma_f32_16x16x32_bf16 v[170:173], v[230:233], v[154:157], v[170:173]
    ds_read_b128 v[150:153], v254 offset:43008
    v_mfma_f32_16x16x32_bf16 v[174:177], v[230:233], v[158:161], v[174:177]
    ds_read_b128 v[154:157], v255 offset:0
    s_waitcnt lgkmcnt(5)
    v_mfma_f32_16x16x32_bf16 v[178:181], v[230:233], v[162:165], v[178:181]
    ds_read_b128 v[158:161], v255 offset:14336
    v_mfma_f32_16x16x32_bf16 v[182:185], v[230:233], v[166:169], v[182:185]
    ds_read_b128 v[162:165], v255 offset:28672
    s_waitcnt lgkmcnt(5)
    v_mfma_f32_16x16x32_bf16 v[170:173], v[234:237], v[138:141], v[170:173]
    ds_read_b128 v[166:169], v255 offset:43008
    v_mfma_f32_16x16x32_bf16 v[174:177], v[234:237], v[142:145], v[174:177]
    ds_read_b64 v[110:111], v94 offset:0
    ds_read_b64 v[112:113], v94 offset:128
    ds_read_b64 v[114:115], v94 offset:256
    s_waitcnt lgkmcnt(7)
    v_mfma_f32_16x16x32_bf16 v[178:181], v[234:237], v[146:149], v[178:181]
    ds_read_b64 v[116:117], v94 offset:384
    ds_read_b64 v[42:43], v96 offset:0
    ds_read_b64 v[44:45], v97 offset:0
    v_mfma_f32_16x16x32_bf16 v[182:185], v[234:237], v[150:153], v[182:185]
    ds_read_b64 v[46:47], v98 offset:0
    ds_read_b64 v[48:49], v99 offset:0
    ds_read_b32 v50, v100
    s_waitcnt lgkmcnt(11)
    v_mfma_f32_16x16x32_bf16 v[170:173], v[238:241], v[154:157], v[170:173]
    ds_read_b32 v51, v101
    ds_read_b64 v[6:7], v102 offset:0
    ds_read_b64 v[8:9], v103 offset:0
    v_mfma_f32_16x16x32_bf16 v[174:177], v[238:241], v[158:161], v[174:177]
    ds_read_b32 v14, v104 offset:0
    s_add_u32 s63, s63, 6144
    buffer_load_dwordx4 v74, s[32:35], s63 offen offset:1024 lds
    ds_read_b32 v15, v105 offset:0
    ds_read_b64 v[10:11], v102 offset:28672
    s_waitcnt lgkmcnt(15)
    v_mfma_f32_16x16x32_bf16 v[178:181], v[238:241], v[162:165], v[178:181]
    ds_read_b64 v[12:13], v103 offset:28672
    ds_read_b32 v16, v104 offset:256
    ds_read_b32 v17, v105 offset:128
    v_mfma_f32_16x16x32_bf16 v[182:185], v[238:241], v[166:169], v[182:185]
    s_lshl_b32 s56, s41, 11
    s_add_u32 s56, s56, s78
    s_add_u32 s56, s56, 393216
    s_waitcnt lgkmcnt(15)
    v_pk_fma_f32 v[170:171], v[62:63], v[110:111], v[170:171] op_sel_hi:[1,0,1] neg_lo:[0,1,0] neg_hi:[0,1,0]
    v_pk_fma_f32 v[172:173], v[64:65], v[110:111], v[172:173] op_sel_hi:[1,0,1] neg_lo:[0,1,0] neg_hi:[0,1,0]
    v_pk_fma_f32 v[174:175], v[62:63], v[112:113], v[174:175] op_sel_hi:[1,0,1] neg_lo:[0,1,0] neg_hi:[0,1,0]
    v_pk_fma_f32 v[176:177], v[64:65], v[112:113], v[176:177] op_sel_hi:[1,0,1] neg_lo:[0,1,0] neg_hi:[0,1,0]
    v_pk_fma_f32 v[178:179], v[62:63], v[114:115], v[178:179] op_sel_hi:[1,0,1] neg_lo:[0,1,0] neg_hi:[0,1,0]
    v_pk_fma_f32 v[180:181], v[64:65], v[114:115], v[180:181] op_sel_hi:[1,0,1] neg_lo:[0,1,0] neg_hi:[0,1,0]
    s_waitcnt lgkmcnt(14)
    v_pk_fma_f32 v[182:183], v[62:63], v[116:117], v[182:183] op_sel_hi:[1,0,1] neg_lo:[0,1,0] neg_hi:[0,1,0]
    v_pk_fma_f32 v[184:185], v[64:65], v[116:117], v[184:185] op_sel_hi:[1,0,1] neg_lo:[0,1,0] neg_hi:[0,1,0]
    v_pk_mul_f32 v[170:171], v[170:171], v[110:111] op_sel:[0,1] op_sel_hi:[1,1]
    v_pk_mul_f32 v[172:173], v[172:173], v[110:111] op_sel:[0,1] op_sel_hi:[1,1]
    v_pk_mul_f32 v[174:175], v[174:175], v[112:113] op_sel:[0,1] op_sel_hi:[1,1]
    v_pk_mul_f32 v[176:177], v[176:177], v[112:113] op_sel:[0,1] op_sel_hi:[1,1]
    v_pk_mul_f32 v[178:179], v[178:179], v[114:115] op_sel:[0,1] op_sel_hi:[1,1]
    v_pk_mul_f32 v[180:181], v[180:181], v[114:115] op_sel:[0,1] op_sel_hi:[1,1]
    v_pk_mul_f32 v[182:183], v[182:183], v[116:117] op_sel:[0,1] op_sel_hi:[1,1]
    v_pk_mul_f32 v[184:185], v[184:185], v[116:117] op_sel:[0,1] op_sel_hi:[1,1]
    v_pk_mul_f32 v[240:241], v[170:171], v[170:171]
    v_pk_mul_f32 v[242:243], v[172:173], v[172:173]
    v_pk_mul_f32 v[244:245], v[174:175], v[174:175]
    v_pk_mul_f32 v[246:247], v[176:177], v[176:177]
    v_pk_mul_f32 v[248:249], v[178:179], v[178:179]
    v_pk_mul_f32 v[250:251], v[180:181], v[180:181]
    v_pk_mul_f32 v[252:253], v[182:183], v[182:183]
    v_pk_mul_f32 v[254:255], v[184:185], v[184:185]
    v_pk_fma_f32 v[240:241], v[240:241], v[108:109], s[82:83]
    v_pk_fma_f32 v[242:243], v[242:243], v[108:109], s[82:83]
    v_pk_fma_f32 v[244:245], v[244:245], v[108:109], s[82:83]
    v_pk_fma_f32 v[246:247], v[246:247], v[108:109], s[82:83]
    v_pk_fma_f32 v[248:249], v[248:249], v[108:109], s[82:83]
    v_pk_fma_f32 v[250:251], v[250:251], v[108:109], s[82:83]
    v_pk_fma_f32 v[252:253], v[252:253], v[108:109], s[82:83]
    v_pk_fma_f32 v[254:255], v[254:255], v[108:109], s[82:83]
    v_pk_mul_f32 v[240:241], v[240:241], v[170:171]
    v_pk_mul_f32 v[242:243], v[242:243], v[172:173]
    v_pk_mul_f32 v[244:245], v[244:245], v[174:175]
    v_pk_mul_f32 v[246:247], v[246:247], v[176:177]
    v_pk_mul_f32 v[248:249], v[248:249], v[178:179]
    v_pk_mul_f32 v[250:251], v[250:251], v[180:181]
    v_pk_mul_f32 v[252:253], v[252:253], v[182:183]
    v_pk_mul_f32 v[254:255], v[254:255], v[184:185]
    v_exp_f32 v240, v240
    v_exp_f32 v241, v241
    s_add_u32 s63, s63, 6144
    buffer_load_dwordx4 v74, s[32:35], s63 offen offset:2048 lds
    v_exp_f32 v242, v242
    v_exp_f32 v243, v243
    v_exp_f32 v244, v244
    v_exp_f32 v245, v245
    v_exp_f32 v246, v246
    v_exp_f32 v247, v247
    v_exp_f32 v248, v248
    v_exp_f32 v249, v249
    v_exp_f32 v250, v250
    v_exp_f32 v251, v251
    v_exp_f32 v252, v252
    v_exp_f32 v253, v253
    v_exp_f32 v254, v254
    v_exp_f32 v255, v255
    v_pk_add_f32 v[240:241], v[240:241], 1.0 op_sel_hi:[1,0]
    v_pk_add_f32 v[242:243], v[242:243], 1.0 op_sel_hi:[1,0]
    v_pk_add_f32 v[244:245], v[244:245], 1.0 op_sel_hi:[1,0]
    v_pk_add_f32 v[246:247], v[246:247], 1.0 op_sel_hi:[1,0]
    v_pk_add_f32 v[248:249], v[248:249], 1.0 op_sel_hi:[1,0]
    v_pk_add_f32 v[250:251], v[250:251], 1.0 op_sel_hi:[1,0]
    v_pk_add_f32 v[252:253], v[252:253], 1.0 op_sel_hi:[1,0]
    v_pk_add_f32 v[254:255], v[254:255], 1.0 op_sel_hi:[1,0]
    v_rcp_f32 v240, v240
    v_rcp_f32 v241, v241
    v_rcp_f32 v242, v242
    v_rcp_f32 v243, v243
    v_rcp_f32 v244, v244
    v_rcp_f32 v245, v245
    v_rcp_f32 v246, v246
    v_rcp_f32 v247, v247
    v_rcp_f32 v248, v248
    v_rcp_f32 v249, v249
    v_rcp_f32 v250, v250
    v_rcp_f32 v251, v251
    v_rcp_f32 v252, v252
    v_rcp_f32 v253, v253
    s_add_u32 s63, s63, 6144
    buffer_load_dwordx4 v74, s[32:35], s63 offen offset:3072 lds
    v_rcp_f32 v254, v254
    v_rcp_f32 v255, v255
    v_pk_mul_f32 v[240:241], v[240:241], v[170:171]
    v_pk_mul_f32 v[242:243], v[242:243], v[172:173]
    v_pk_mul_f32 v[244:245], v[244:245], v[174:175]
    v_pk_mul_f32 v[246:247], v[246:247], v[176:177]
    v_pk_mul_f32 v[248:249], v[248:249], v[178:179]
    v_pk_mul_f32 v[250:251], v[250:251], v[180:181]
    v_pk_mul_f32 v[252:253], v[252:253], v[182:183]
    v_pk_mul_f32 v[254:255], v[254:255], v[184:185]
    v_cvt_pk_bf16_f32 v76, v240, v241
    v_cvt_pk_bf16_f32 v77, v242, v243
    v_cvt_pk_bf16_f32 v78, v244, v245
    v_cvt_pk_bf16_f32 v79, v246, v247
    v_min_u32 v1, 6, v0
    v_lshlrev_b32 v1, 7, v1
    s_add_u32 s42, s74, 32768
    buffer_load_dword v66, v1, s[48:51], s42 offen sc1
    v_cvt_pk_bf16_f32 v80, v248, v249
    v_cvt_pk_bf16_f32 v81, v250, v251
    v_min_u32 v67, 3, v0
    v_lshlrev_b32 v67, 7, v67
    s_add_u32 s43, s81, 65536
    buffer_load_dword v68, v67, s[48:51], s43 offen sc1
    v_cvt_pk_bf16_f32 v82, v252, v253
    v_cvt_pk_bf16_f32 v83, v254, v255
    v_permlane16_swap_b32 v76, v78
    v_permlane16_swap_b32 v77, v79
    v_permlane16_swap_b32 v80, v82
    v_permlane16_swap_b32 v81, v83
    buffer_store_dwordx4 v[76:79], v5, s[48:51], s56 offen offset:0 sc1
    buffer_store_dwordx4 v[80:83], v5, s[48:51], s56 offen offset:1024 sc1
    s_waitcnt vmcnt(15)
    s_waitcnt lgkmcnt(0)
    s_barrier
    v_add_u32 v62, 57344, v73
    v_xor_b32 v63, 64, v62
    s_lshl_b32 s56, s41, 16
    s_lshl_b32 s57, s54, 7
    s_sub_u32 s56, s56, s57
    s_add_u32 s56, s56, 4329344
    ds_read_b64_tr_b16 v[108:109], v62 offset:0
    s_add_u32 m0, s27, 69248
    s_add_u32 s63, s63, 10240
    buffer_load_dwordx4 v74, s[32:35], s63 offen offset:0 lds
    ds_read_b64_tr_b16 v[110:111], v62 offset:512
    ds_read_b64_tr_b16 v[112:113], v63 offset:1024
    ds_read_b64_tr_b16 v[76:77], v62 offset:9216
    ds_read_b64_tr_b16 v[78:79], v62 offset:9728
    ds_read_b64_tr_b16 v[114:115], v62 offset:4096
    ds_read_b64_tr_b16 v[116:117], v62 offset:4608
    ds_read_b64_tr_b16 v[118:119], v63 offset:5120
    ds_read_b64_tr_b16 v[80:81], v62 offset:13312
    ds_read_b64_tr_b16 v[82:83], v62 offset:13824
    v_lshlrev_b32 v88, 16, v86
    v_and_b32 v89, 0xffff0000, v86
    v_lshlrev_b32 v90, 16, v87
    v_and_b32 v91, 0xffff0000, v87
    s_add_u32 s63, s63, 6144
    buffer_load_dwordx4 v74, s[32:35], s63 offen offset:1024 lds
    s_waitcnt lgkmcnt(9)
    v_and_b32 v121, 0xffff0000, v108
    v_lshlrev_b32 v122, 16, v109
    v_and_b32 v123, 0xffff0000, v109
    s_waitcnt lgkmcnt(8)
    v_lshlrev_b32 v124, 16, v110
    v_and_b32 v125, 0xffff0000, v110
    v_lshlrev_b32 v126, 16, v111
    v_and_b32 v127, 0xffff0000, v111
    s_waitcnt lgkmcnt(7)
    v_lshlrev_b32 v128, 16, v112
    s_add_u32 s63, s63, 6144
    buffer_load_dwordx4 v74, s[32:35], s63 offen offset:2048 lds
    v_and_b32 v129, 0xffff0000, v112
    v_lshlrev_b32 v130, 16, v113
    v_and_b32 v131, 0xffff0000, v113
    s_waitcnt lgkmcnt(6)
    v_lshlrev_b32 v96, 16, v76
    v_and_b32 v97, 0xffff0000, v76
    v_lshlrev_b32 v98, 16, v77
    v_and_b32 v99, 0xffff0000, v77
    s_waitcnt lgkmcnt(5)
    v_lshlrev_b32 v100, 16, v78
    v_and_b32 v101, 0xffff0000, v78
    v_lshlrev_b32 v102, 16, v79
    v_and_b32 v103, 0xffff0000, v79
    v_mul_f32 v131, v88, v131
    v_fmac_f32 v131, v89, v130
    v_fmac_f32 v131, v90, v129
    v_fmac_f32 v131, v91, v128
    s_add_u32 s63, s63, 6144
    buffer_load_dwordx4 v74, s[32:35], s63 offen offset:3072 lds
    v_mul_f32 v103, v103, v131
    v_mul_f32 v130, v88, v130
    v_fmac_f32 v130, v89, v129
    v_fmac_f32 v130, v90, v128
    v_fmac_f32 v130, v91, v127
    v_mul_f32 v102, v102, v130
    v_mul_f32 v129, v88, v129
    v_fmac_f32 v129, v89, v128
    v_fmac_f32 v129, v90, v127
    v_fmac_f32 v129, v91, v126
    v_mul_f32 v101, v101, v129
    v_mul_f32 v128, v88, v128
    s_add_u32 m0, s27, 73344
    s_add_u32 s63, s63, 10240
    buffer_load_dwordx4 v74, s[32:35], s63 offen offset:0 lds
    v_fmac_f32 v128, v89, v127
    v_fmac_f32 v128, v90, v126
    v_fmac_f32 v128, v91, v125
    v_mul_f32 v100, v100, v128
    v_mul_f32 v127, v88, v127
    v_fmac_f32 v127, v89, v126
    v_fmac_f32 v127, v90, v125
    v_fmac_f32 v127, v91, v124
    v_mul_f32 v99, v99, v127
    v_mul_f32 v126, v88, v126
    v_fmac_f32 v126, v89, v125
    v_fmac_f32 v126, v90, v124
    v_fmac_f32 v126, v91, v123
    s_add_u32 s63, s63, 6144
    buffer_load_dwordx4 v74, s[32:35], s63 offen offset:1024 lds
    v_mul_f32 v98, v98, v126
    v_mul_f32 v125, v88, v125
    v_fmac_f32 v125, v89, v124
    v_fmac_f32 v125, v90, v123
    v_fmac_f32 v125, v91, v122
    v_mul_f32 v97, v97, v125
    v_mul_f32 v124, v88, v124
    v_fmac_f32 v124, v89, v123
    v_fmac_f32 v124, v90, v122
    v_fmac_f32 v124, v91, v121
    v_mul_f32 v96, v96, v124
    v_cvt_pk_bf16_f32 v54, v103, v102
    v_cvt_pk_bf16_f32 v55, v101, v100
    v_cvt_pk_bf16_f32 v56, v99, v98
    v_cvt_pk_bf16_f32 v57, v97, v96
    ds_write_b128 v106, v[54:57]
    s_waitcnt lgkmcnt(5)
    v_and_b32 v121, 0xffff0000, v114
    v_lshlrev_b32 v122, 16, v115
    v_and_b32 v123, 0xffff0000, v115
    s_waitcnt lgkmcnt(4)
    v_lshlrev_b32 v124, 16, v116
    v_and_b32 v125, 0xffff0000, v116
    v_lshlrev_b32 v126, 16, v117
    v_and_b32 v127, 0xffff0000, v117
    s_waitcnt lgkmcnt(3)
    v_lshlrev_b32 v128, 16, v118
    v_and_b32 v129, 0xffff0000, v118
    v_lshlrev_b32 v130, 16, v119
    v_and_b32 v131, 0xffff0000, v119
    s_waitcnt lgkmcnt(2)
    v_lshlrev_b32 v96, 16, v80
    v_and_b32 v97, 0xffff0000, v80
    v_lshlrev_b32 v98, 16, v81
    v_and_b32 v99, 0xffff0000, v81
    s_waitcnt lgkmcnt(1)
    v_lshlrev_b32 v100, 16, v82
    v_and_b32 v101, 0xffff0000, v82
    v_lshlrev_b32 v102, 16, v83
    v_and_b32 v103, 0xffff0000, v83
    v_mul_f32 v131, v88, v131
    v_fmac_f32 v131, v89, v130
    v_fmac_f32 v131, v90, v129
    v_fmac_f32 v131, v91, v128
    v_mul_f32 v103, v103, v131
    v_mul_f32 v130, v88, v130
    v_fmac_f32 v130, v89, v129
    v_fmac_f32 v130, v90, v128
    v_fmac_f32 v130, v91, v127
    v_mul_f32 v102, v102, v130
    v_mul_f32 v129, v88, v129
    v_fmac_f32 v129, v89, v128
    v_fmac_f32 v129, v90, v127
    v_fmac_f32 v129, v91, v126
    buffer_load_dword v40, v40, s[20:23], 0 offen
    v_mul_f32 v101, v101, v129
    v_mul_f32 v128, v88, v128
    v_fmac_f32 v128, v89, v127
    v_fmac_f32 v128, v90, v126
    v_fmac_f32 v128, v91, v125
    v_mul_f32 v100, v100, v128
    v_mul_f32 v127, v88, v127
    v_fmac_f32 v127, v89, v126
    v_fmac_f32 v127, v90, v125
    v_fmac_f32 v127, v91, v124
    v_mul_f32 v99, v99, v127
    v_mul_f32 v126, v88, v126
    v_fmac_f32 v126, v89, v125
    v_fmac_f32 v126, v90, v124
    v_fmac_f32 v126, v91, v123
    v_mul_f32 v98, v98, v126
    v_mul_f32 v125, v88, v125
    v_fmac_f32 v125, v89, v124
    v_fmac_f32 v125, v90, v123
    v_fmac_f32 v125, v91, v122
    v_mul_f32 v97, v97, v125
    v_mul_f32 v124, v88, v124
    v_fmac_f32 v124, v89, v123
    v_fmac_f32 v124, v90, v122
    v_fmac_f32 v124, v91, v121
    v_mul_f32 v96, v96, v124
    v_cvt_pk_bf16_f32 v58, v103, v102
    v_cvt_pk_bf16_f32 v59, v101, v100
    v_cvt_pk_bf16_f32 v60, v99, v98
    v_cvt_pk_bf16_f32 v61, v97, v96
    ds_write_b128 v107, v[58:61]
    ds_read_b128 v[54:57], v95 offset:0
    ds_read_b128 v[58:61], v95 offset:1024
    s_add_u32 s57, s56, 32768
    s_waitcnt lgkmcnt(1)
    buffer_store_dwordx4 v[54:57], v41, s[48:51], s56 offen sc1
    s_waitcnt lgkmcnt(0)
    buffer_store_dwordx4 v[58:61], v41, s[48:51], s57 offen sc1
    s_mov_b32 s60, -1
    s_waitcnt vmcnt(12)
    v_subrev_u32 v66, s55, v66
    v_subrev_u32 v4, 1, v66
    v_cmp_lt_u32 vcc, 15, v4
    s_nop 0
    s_and_b32 s61, vcc_lo, s60
    s_cbranch_scc0 Lskip_1
    s_mov_b32 s59, 0
    s_nop 1
Lloop_2:
    s_sleep 4
    buffer_load_dword v66, v1, s[48:51], s42 offen sc1
    s_add_u32 s59, s59, 1
    s_waitcnt vmcnt(0)
    v_subrev_u32 v66, s55, v66
    v_subrev_u32 v4, 1, v66
    v_cmp_lt_u32 vcc, 15, v4
    s_nop 0
    s_and_b32 s61, vcc_lo, s60
    s_cselect_b32 s61, s59, 0x40000
    s_cmp_lt_u32 s61, 0x40000
    s_cbranch_scc1 Lloop_2
Lskip_1:
    s_sub_u32 s36, s36, s55
    v_cmp_ne_u32 s[84:85], s36, v66
    s_waitcnt vmcnt(9)
    s_mov_b64 exec, 1
    s_cmp_eq_u32 s84, 0
    s_cbranch_scc1 Lfa_3
    buffer_store_dword v19, off, s[48:51], s75 offset:0 sc1
    s_branch Lfb_4
Lfa_3:
    buffer_store_dword v19, off, s[48:51], s75 offset:0
Lfb_4:
    s_mov_b64 exec, -1
    s_mov_b32 s60, -1
    v_cmp_ne_u32 vcc, s55, v68
    s_nop 0
    s_and_b32 s61, vcc_lo, s60
    s_cbranch_scc0 Lskip_5
    s_mov_b32 s59, 0
    s_nop 1
Lloop_6:
    s_sleep 4
    buffer_load_dword v68, v67, s[48:51], s43 offen sc1
    s_add_u32 s59, s59, 1
    s_waitcnt vmcnt(0)
    v_cmp_ne_u32 vcc, s55, v68
    s_nop 0
    s_and_b32 s61, vcc_lo, s60
    s_cselect_b32 s61, s59, 0x40000
    s_cmp_lt_u32 s61, 0x40000
    s_cbranch_scc1 Lloop_6
Lskip_5:
    buffer_load_dwordx4 a[0:3], v5, s[48:51], s80 offen offset:0 sc1
    buffer_load_dwordx4 a[8:11], v5, s[48:51], s80 offen offset:1024 sc1
    buffer_load_dwordx4 a[16:19], v5, s[48:51], s80 offen offset:2048 sc1
    buffer_load_dwordx4 a[24:27], v5, s[48:51], s80 offen offset:3072 sc1
    s_add_u32 s80, s80, 4096
    buffer_load_dwordx4 a[32:35], v5, s[48:51], s80 offen offset:0 sc1
    buffer_load_dwordx4 a[40:43], v5, s[48:51], s80 offen offset:1024 sc1
    s_waitcnt vmcnt(10)
    s_barrier
    ds_write_b128 v25, v[28:31] offset:13536
    buffer_load_dwordx4 a[48:51], v5, s[48:51], s80 offen offset:2048 sc1
    ds_read_b64_tr_b16 a[224:225], v52 offset:0
    ds_read_b64_tr_b16 a[226:227], v52 offset:512
    ds_read_b64_tr_b16 a[228:229], v53 offset:0
    ds_read_b64_tr_b16 a[230:231], v53 offset:512
    ds_read_b64_tr_b16 a[232:233], v52 offset:2048
    ds_read_b64_tr_b16 a[234:235], v52 offset:2560
    s_add_u32 s27, s74, 0
    buffer_load_dword v1, v18, s[48:51], s27 offen sc1
    ds_write_b128 v25, v[34:37] offset:14560
    ds_read_b64_tr_b16 a[236:237], v53 offset:2048
    ds_read_b64_tr_b16 a[238:239], v53 offset:2560
    ds_read_b64_tr_b16 a[240:241], v52 offset:8192
    ds_read_b64_tr_b16 a[242:243], v52 offset:8704
    ds_read_b64_tr_b16 a[244:245], v53 offset:8192
    ds_read_b64_tr_b16 a[246:247], v53 offset:8704
    v_mov_b32_dpp v26, v30 wave_shr:1 row_mask:0xf bank_mask:0xf
    v_mov_b32_dpp v27, v31 wave_shr:1 row_mask:0xf bank_mask:0xf
    v_mov_b32_dpp v32, v36 wave_shr:1 row_mask:0xf bank_mask:0xf
    v_mov_b32_dpp v33, v37 wave_shr:1 row_mask:0xf bank_mask:0xf
    s_waitcnt vmcnt(11)
    v_readlane_b32 s58, v40, 0
    v_readlane_b32 s59, v40, 1
    v_readlane_b32 s60, v30, 63
    v_readlane_b32 s61, v31, 63
    s_nop 0
    v_writelane_b32 v26, s58, 0
    v_writelane_b32 v27, s59, 0
    v_writelane_b32 v32, s60, 0
    v_writelane_b32 v33, s61, 0
    v_alignbyte_b32 v70, v27, v26, 2
    v_alignbyte_b32 v71, v28, v27, 2
    v_alignbyte_b32 v72, v29, v28, 2
    v_alignbyte_b32 v73, v30, v29, 2
    v_mov_b32 v74, v27
    v_mov_b32 v75, v28
    v_mov_b32 v76, v29
    v_mov_b32 v77, v30
    v_alignbyte_b32 v78, v28, v27, 2
    v_alignbyte_b32 v79, v29, v28, 2
    v_alignbyte_b32 v80, v30, v29, 2
    v_alignbyte_b32 v81, v31, v30, 2
    ds_write_b128 v25, v[70:73] offset:0
    ds_read_b64_tr_b16 a[248:249], v52 offset:10240
    ds_read_b64_tr_b16 a[250:251], v52 offset:10752
    ds_read_b64_tr_b16 a[252:253], v53 offset:10240
    ds_read_b64_tr_b16 a[254:255], v53 offset:10752
    ds_read_b64_tr_b16 v[176:177], v52 offset:16384
    ds_read_b64_tr_b16 v[178:179], v52 offset:16896
    ds_write_b128 v25, v[74:77] offset:4512
    ds_read_b64_tr_b16 v[180:181], v53 offset:16384
    buffer_load_dword v62, v18, s[48:51], s27 offen sc1
    ds_read_b64_tr_b16 v[182:183], v53 offset:16896
    ds_read_b64_tr_b16 v[184:185], v52 offset:18432
    ds_read_b64_tr_b16 v[186:187], v52 offset:18944
    ds_read_b64_tr_b16 v[188:189], v53 offset:18432
    ds_read_b64_tr_b16 v[190:191], v53 offset:18944
    ds_write_b128 v25, v[78:81] offset:9024
    ds_read_b64_tr_b16 v[192:193], v52 offset:24576
    buffer_load_dwordx4 a[56:59], v5, s[48:51], s80 offen offset:3072 sc1
    ds_read_b64_tr_b16 v[194:195], v52 offset:25088
    ds_read_b64_tr_b16 v[196:197], v53 offset:24576
    ds_read_b64_tr_b16 v[198:199], v53 offset:25088
    ds_read_b64_tr_b16 v[200:201], v52 offset:26624
    ds_read_b64_tr_b16 v[202:203], v52 offset:27136
    v_alignbyte_b32 v70, v33, v32, 2
    v_alignbyte_b32 v71, v34, v33, 2
    v_alignbyte_b32 v72, v35, v34, 2
    v_alignbyte_b32 v73, v36, v35, 2
    v_mov_b32 v74, v33
    v_mov_b32 v75, v34
    v_mov_b32 v76, v35
    s_add_u32 s80, s80, 4096
    buffer_load_dwordx4 a[64:67], v5, s[48:51], s80 offen offset:0 sc1
    s_add_u32 s61, s76, 131072
    s_waitcnt vmcnt(12)
    buffer_store_dword v19, v18, s[48:51], s61 offen sc1
    buffer_load_dword v63, v18, s[48:51], s27 offen sc1
    v_mov_b32 v77, v36
    v_alignbyte_b32 v78, v34, v33, 2
    v_alignbyte_b32 v79, v35, v34, 2
    v_alignbyte_b32 v80, v36, v35, 2
    v_alignbyte_b32 v81, v37, v36, 2
    ds_write_b128 v25, v[70:73] offset:1024
    ds_read_b64_tr_b16 v[204:205], v53 offset:26624
    ds_read_b64_tr_b16 v[206:207], v53 offset:27136
    ds_read_b64_tr_b16 v[208:209], v52 offset:32768
    ds_read_b64_tr_b16 v[210:211], v52 offset:33280
    ds_read_b64_tr_b16 v[212:213], v53 offset:32768
    ds_read_b64_tr_b16 v[214:215], v53 offset:33280
    buffer_load_dwordx4 a[72:75], v5, s[48:51], s80 offen offset:1024 sc1
    ds_write_b128 v25, v[74:77] offset:5536
    buffer_load_dwordx4 a[80:83], v5, s[48:51], s80 offen offset:2048 sc1
    ds_read_b64_tr_b16 v[216:217], v52 offset:34816
    ds_read_b64_tr_b16 v[218:219], v52 offset:35328
    buffer_load_dwordx4 a[88:91], v5, s[48:51], s80 offen offset:3072 sc1
    ds_read_b64_tr_b16 v[220:221], v53 offset:34816
    ds_read_b64_tr_b16 v[222:223], v53 offset:35328
    ds_read_b64_tr_b16 v[224:225], v52 offset:40960
    ds_read_b64_tr_b16 v[226:227], v52 offset:41472
    ds_write_b128 v25, v[78:81] offset:10048
    ds_read_b64_tr_b16 v[228:229], v53 offset:40960
    s_add_u32 s80, s80, 4096
    buffer_load_dwordx4 a[96:99], v5, s[48:51], s80 offen offset:0 sc1
    s_lshl_b32 s60, s72, 1
    s_lshl_b32 s60, 0x3333333, s60
    s_waitcnt vmcnt(9)
    v_cmp_ne_u32 vcc, s55, v1
    s_nop 0
    s_and_b32 s61, vcc_lo, s60
    s_cbranch_scc0 Lskip_7
    s_waitcnt vmcnt(8)
    v_cmp_ne_u32 vcc, s55, v62
    s_nop 0
    s_and_b32 s61, vcc_lo, s60
    s_cbranch_scc0 Lskip_8
    s_waitcnt vmcnt(4)
    v_cmp_ne_u32 vcc, s55, v63
    s_nop 0
    s_and_b32 s61, vcc_lo, s60
    s_cbranch_scc0 Lskip_9
    s_mov_b32 s59, 0
    s_nop 1
Lloop_10:
    buffer_load_dword v1, v18, s[48:51], s27 offen sc1
    s_add_u32 s59, s59, 1
    s_waitcnt vmcnt(0)
    v_cmp_ne_u32 vcc, s55, v1
    s_nop 0
    s_and_b32 s61, vcc_lo, s60
    s_cselect_b32 s61, s59, 0x40000
    s_cmp_lt_u32 s61, 0x40000
    s_cbranch_scc1 Lloop_10
Lskip_9:
Lskip_8:
Lskip_7:
    s_lshl_b32 s56, s72, 12
    s_add_u32 s56, s56, s78
    s_lshl_b32 s57, s73, 10
    s_add_u32 s56, s56, s57
    s_add_u32 s62, s56, 393216
    ds_read_b64_tr_b16 v[230:231], v53 offset:41472
    buffer_load_dwordx4 v[88:91], v5, s[48:51], s62 offen offset:0 sc1
    ds_read_b64_tr_b16 v[232:233], v52 offset:43008
    buffer_load_dwordx4 v[92:95], v5, s[48:51], s62 offen offset:2048 sc1
    ds_read_b64_tr_b16 v[234:235], v52 offset:43520
    s_add_u32 s62, s62, 8192
    buffer_load_dwordx4 v[96:99], v5, s[48:51], s62 offen offset:0 sc1
    ds_read_b64_tr_b16 v[236:237], v53 offset:43008
    ds_read_b64_tr_b16 v[238:239], v53 offset:43520
    v_mov_b32 v26, 0
    v_mov_b32 v27, 0
    v_mov_b32 v28, 0
    v_mov_b32 v29, 0
    ds_write_b128 v38, v[26:29]
    ds_read_b64_tr_b16 v[240:241], v52 offset:49152
    ds_read_b64_tr_b16 v[242:243], v52 offset:49664
    ds_read_b64_tr_b16 v[244:245], v53 offset:49152
    ds_read_b64_tr_b16 v[246:247], v53 offset:49664
    ds_read_b64_tr_b16 v[248:249], v52 offset:51200
    buffer_load_dwordx4 v[100:103], v5, s[48:51], s62 offen offset:2048 sc1
    ds_read_b64_tr_b16 v[250:251], v52 offset:51712
    ds_write_b128 v39, v[26:29]
    ds_read_b64_tr_b16 v[252:253], v53 offset:51200
    ds_read_b64_tr_b16 v[254:255], v53 offset:51712
    v_lshlrev_b32 v144, 16, v42
    s_add_u32 s62, s62, 8192
    buffer_load_dwordx4 v[104:107], v5, s[48:51], s62 offen offset:0 sc1
    v_and_b32 v145, 0xffff0000, v42
    v_lshlrev_b32 v146, 16, v43
    v_and_b32 v147, 0xffff0000, v43
    v_lshlrev_b32 v148, 16, v44
    v_and_b32 v149, 0xffff0000, v44
    v_lshlrev_b32 v150, 16, v45
    v_and_b32 v151, 0xffff0000, v45
    v_lshlrev_b32 v152, 16, v46
    v_and_b32 v153, 0xffff0000, v46
    v_lshlrev_b32 v154, 16, v47
    v_and_b32 v155, 0xffff0000, v47
    v_lshlrev_b32 v156, 16, v48
    v_and_b32 v157, 0xffff0000, v48
    v_lshlrev_b32 v158, 16, v49
    v_and_b32 v159, 0xffff0000, v49
    v_mul_f32 v50, v50, v51
    v_pk_fma_f32 v[144:145], v[144:145], v[50:51], v[50:51] op_sel:[0,1,0] op_sel_hi:[1,1,0] neg_lo:[0,0,1] neg_hi:[0,0,1]
    v_pk_fma_f32 v[146:147], v[146:147], v[50:51], v[50:51] op_sel:[0,1,0] op_sel_hi:[1,1,0] neg_lo:[0,0,1] neg_hi:[0,0,1]
    v_pk_fma_f32 v[148:149], v[148:149], v[50:51], v[50:51] op_sel:[0,1,0] op_sel_hi:[1,1,0] neg_lo:[0,0,1] neg_hi:[0,0,1]
    v_pk_fma_f32 v[150:151], v[150:151], v[50:51], v[50:51] op_sel:[0,1,0] op_sel_hi:[1,1,0] neg_lo:[0,0,1] neg_hi:[0,0,1]
    v_pk_fma_f32 v[152:153], v[152:153], v[50:51], v[50:51] op_sel:[0,1,0] op_sel_hi:[1,1,0] neg_lo:[0,0,1] neg_hi:[0,0,1]
    buffer_load_dwordx4 v[108:111], v5, s[48:51], s62 offen offset:2048 sc1
    v_pk_fma_f32 v[154:155], v[154:155], v[50:51], v[50:51] op_sel:[0,1,0] op_sel_hi:[1,1,0] neg_lo:[0,0,1] neg_hi:[0,0,1]
    v_pk_fma_f32 v[156:157], v[156:157], v[50:51], v[50:51] op_sel:[0,1,0] op_sel_hi:[1,1,0] neg_lo:[0,0,1] neg_hi:[0,0,1]
    v_pk_fma_f32 v[158:159], v[158:159], v[50:51], v[50:51] op_sel:[0,1,0] op_sel_hi:[1,1,0] neg_lo:[0,0,1] neg_hi:[0,0,1]
    s_add_u32 s62, s62, 8192
    buffer_load_dwordx4 v[112:115], v5, s[48:51], s62 offen offset:0 sc1
    buffer_load_dwordx4 v[116:119], v5, s[48:51], s62 offen offset:2048 sc1
    s_add_u32 s62, s62, 8192
    buffer_load_dwordx4 v[120:123], v5, s[48:51], s62 offen offset:0 sc1
    buffer_load_dwordx4 v[124:127], v5, s[48:51], s62 offen offset:2048 sc1
    s_waitcnt vmcnt(9) lgkmcnt(15)
    v_mfma_f32_32x32x16_bf16 v[160:175], a[228:231], v[88:91], 0
    s_lshl_b32 s58, s53, 13
    v_mfma_f32_32x32x16_bf16 v[144:159], a[224:227], v[88:91], v[144:159]
    s_add_u32 s56, s56, s58
    s_waitcnt vmcnt(8)
    v_mfma_f32_32x32x16_bf16 v[160:175], a[236:239], v[92:95], v[160:175]
    s_add_u32 s62, s62, 8192
    buffer_load_dwordx4 v[128:131], v5, s[48:51], s62 offen offset:0 sc1
    s_add_u32 s56, s56, 2228224
    v_mfma_f32_32x32x16_bf16 v[144:159], a[232:235], v[92:95], v[144:159]
    s_xor_b32 s58, s52, 1
    s_waitcnt vmcnt(8)
    v_mfma_f32_32x32x16_bf16 v[160:175], a[244:247], v[96:99], v[160:175]
    buffer_load_dwordx4 v[132:135], v5, s[48:51], s62 offen offset:2048 sc1
    s_lshl_b32 s58, s58, 12
    v_mfma_f32_32x32x16_bf16 v[144:159], a[240:243], v[96:99], v[144:159]
    v_add_u32 v2, s58, v5
    s_waitcnt vmcnt(8)
    v_mfma_f32_32x32x16_bf16 v[160:175], a[252:255], v[100:103], v[160:175]
    s_add_u32 s62, s62, 8192
    buffer_load_dwordx4 v[136:139], v5, s[48:51], s62 offen offset:0 sc1
    v_xor_b32 v3, 4096, v2
    s_lshl_b32 s57, s54, 13
    v_mfma_f32_32x32x16_bf16 v[144:159], a[248:251], v[100:103], v[144:159]
    s_mul_i32 s58, s73, 3584
    s_waitcnt vmcnt(8)
    v_mfma_f32_32x32x16_bf16 v[160:175], v[180:183], v[104:107], v[160:175]
    buffer_load_dwordx4 v[140:143], v5, s[48:51], s62 offen offset:2048 sc1
    s_add_u32 s57, s57, s58
    v_mfma_f32_32x32x16_bf16 v[144:159], v[176:179], v[104:107], v[144:159]
    s_lshl_b32 s58, s53, 9
    s_waitcnt vmcnt(8)
    v_mfma_f32_32x32x16_bf16 v[160:175], v[188:191], v[108:111], v[160:175]
    buffer_load_dwordx4 a[104:107], v5, s[48:51], s80 offen offset:1024 sc1
    s_add_u32 s57, s57, s58
    v_mfma_f32_32x32x16_bf16 v[144:159], v[184:187], v[108:111], v[144:159]
    s_lshl_b32 s58, s72, 8
    s_waitcnt vmcnt(8)
    v_mfma_f32_32x32x16_bf16 v[160:175], v[196:199], v[112:115], v[160:175]
    buffer_load_dwordx4 a[112:115], v5, s[48:51], s80 offen offset:2048 sc1
    s_add_u32 s57, s57, s58
    s_add_u32 s57, s57, 4063232
    v_mfma_f32_32x32x16_bf16 v[144:159], v[192:195], v[112:115], v[144:159]
    s_waitcnt vmcnt(8)
    v_mfma_f32_32x32x16_bf16 v[160:175], v[204:207], v[116:119], v[160:175]
    buffer_load_dwordx4 a[120:123], v5, s[48:51], s80 offen offset:3072 sc1
    v_mfma_f32_32x32x16_bf16 v[144:159], v[200:203], v[116:119], v[144:159]
    s_waitcnt vmcnt(8)
    v_mfma_f32_32x32x16_bf16 v[160:175], v[212:215], v[120:123], v[160:175]
    s_add_u32 s80, s80, 4096
    buffer_load_dwordx4 a[128:131], v5, s[48:51], s80 offen offset:0 sc1
    v_mfma_f32_32x32x16_bf16 v[144:159], v[208:211], v[120:123], v[144:159]
    s_waitcnt vmcnt(8)
    v_mfma_f32_32x32x16_bf16 v[160:175], v[220:223], v[124:127], v[160:175]
    buffer_load_dwordx4 a[136:139], v5, s[48:51], s80 offen offset:1024 sc1
    v_mfma_f32_32x32x16_bf16 v[144:159], v[216:219], v[124:127], v[144:159]
    s_waitcnt vmcnt(8) lgkmcnt(14)
    v_mfma_f32_32x32x16_bf16 v[160:175], v[228:231], v[128:131], v[160:175]
    buffer_load_dwordx4 a[144:147], v5, s[48:51], s80 offen offset:2048 sc1
    v_mfma_f32_32x32x16_bf16 v[144:159], v[224:227], v[128:131], v[144:159]
    s_waitcnt vmcnt(8) lgkmcnt(10)
    v_mfma_f32_32x32x16_bf16 v[160:175], v[236:239], v[132:135], v[160:175]
    v_min_u32 v1, 3, v0
    v_lshlrev_b32 v1, 7, v1
    s_add_u32 s27, s81, 66048
    buffer_load_dword v25, v1, s[48:51], s27 offen sc1
    buffer_load_dwordx4 a[152:155], v5, s[48:51], s80 offen offset:3072 sc1
    v_mfma_f32_32x32x16_bf16 v[144:159], v[232:235], v[132:135], v[144:159]
    s_xor_b32 s59, s72, 1
    s_lshl_b32 s59, s59, 11
    v_min_u32 v26, 15, v0
    v_lshlrev_b32 v26, 7, v26
    s_add_u32 s36, s77, 131072
    s_add_u32 s36, s36, s59
    buffer_load_dword v27, v26, s[48:51], s36 offen sc1
    s_waitcnt vmcnt(10) lgkmcnt(5)
    v_mfma_f32_32x32x16_bf16 v[160:175], v[244:247], v[136:139], v[160:175]
    s_add_u32 s80, s80, 4096
    buffer_load_dwordx4 a[160:163], v5, s[48:51], s80 offen offset:0 sc1
    v_mfma_f32_32x32x16_bf16 v[144:159], v[240:243], v[136:139], v[144:159]
    s_waitcnt vmcnt(10) lgkmcnt(0)
    v_mfma_f32_32x32x16_bf16 v[160:175], v[252:255], v[140:143], v[160:175]
    buffer_load_dwordx4 a[168:171], v5, s[48:51], s80 offen offset:1024 sc1
    v_mfma_f32_32x32x16_bf16 v[144:159], v[248:251], v[140:143], v[144:159]
    s_nop 9
    ds_write_b128 v2, v[160:163] offset:0
    buffer_load_dwordx4 a[176:179], v5, s[48:51], s80 offen offset:2048 sc1
    ds_write_b128 v2, v[164:167] offset:1024
    ds_write_b128 v2, v[168:171] offset:2048
    ds_write_b128 v2, v[172:175] offset:3072
    buffer_load_dwordx4 a[184:187], v5, s[48:51], s80 offen offset:3072 sc1
    s_waitcnt lgkmcnt(0)
    s_barrier
    ds_read_b128 v[160:163], v3 offset:0
    s_add_u32 s80, s80, 4096
    buffer_load_dwordx4 a[192:195], v5, s[48:51], s80 offen offset:0 sc1
    ds_read_b128 v[164:167], v3 offset:1024
    ds_read_b128 v[168:171], v3 offset:2048
    ds_read_b128 v[172:175], v3 offset:3072
    s_waitcnt lgkmcnt(3)
    v_pk_add_f32 v[144:145], v[144:145], v[160:161]
    v_pk_add_f32 v[146:147], v[146:147], v[162:163]
    s_waitcnt lgkmcnt(2)
    v_pk_add_f32 v[148:149], v[148:149], v[164:165]
    v_pk_add_f32 v[150:151], v[150:151], v[166:167]
    v_cvt_pk_bf16_f32 v28, v144, v145
    v_cvt_pk_bf16_f32 v29, v146, v147
    v_cvt_pk_bf16_f32 v30, v148, v149
    v_cvt_pk_bf16_f32 v31, v150, v151
    buffer_store_dwordx4 v[28:31], v5, s[48:51], s56 offen offset:0 sc1
    s_waitcnt lgkmcnt(1)
    v_pk_add_f32 v[152:153], v[152:153], v[168:169]
    v_pk_add_f32 v[154:155], v[154:155], v[170:171]
    s_waitcnt lgkmcnt(0)
    v_pk_add_f32 v[156:157], v[156:157], v[172:173]
    v_pk_add_f32 v[158:159], v[158:159], v[174:175]
    v_cvt_pk_bf16_f32 v32, v152, v153
    v_cvt_pk_bf16_f32 v33, v154, v155
    v_cvt_pk_bf16_f32 v34, v156, v157
    v_cvt_pk_bf16_f32 v35, v158, v159
    buffer_store_dwordx4 v[32:35], v5, s[48:51], s56 offen offset:2048 sc1
    v_pk_add_f32 v[160:161], v[144:145], v[146:147]
    v_pk_mul_f32 v[162:163], v[144:145], v[144:145]
    v_pk_fma_f32 v[162:163], v[146:147], v[146:147], v[162:163]
    v_pk_add_f32 v[160:161], v[160:161], v[148:149]
    v_pk_fma_f32 v[162:163], v[148:149], v[148:149], v[162:163]
    v_pk_add_f32 v[160:161], v[160:161], v[150:151]
    v_pk_fma_f32 v[162:163], v[150:151], v[150:151], v[162:163]
    v_pk_add_f32 v[160:161], v[160:161], v[152:153]
    v_pk_fma_f32 v[162:163], v[152:153], v[152:153], v[162:163]
    v_pk_add_f32 v[160:161], v[160:161], v[154:155]
    v_pk_fma_f32 v[162:163], v[154:155], v[154:155], v[162:163]
    v_pk_add_f32 v[160:161], v[160:161], v[156:157]
    v_pk_fma_f32 v[162:163], v[156:157], v[156:157], v[162:163]
    v_pk_add_f32 v[160:161], v[160:161], v[158:159]
    v_pk_fma_f32 v[162:163], v[158:159], v[158:159], v[162:163]
    v_add_f32 v36, v160, v161
    v_add_f32 v37, v162, v163
    s_nop 1
    v_permlane32_swap_b32 v36, v37
    v_add_f32 v36, v36, v37
    buffer_store_dword v36, v22, s[48:51], s57 offen sc1
    s_mov_b32 s60, -1
    s_waitcnt vmcnt(8)
    v_cmp_ne_u32 vcc, s55, v27
    s_nop 0
    s_and_b32 s61, vcc_lo, s60
    s_cbranch_scc0 Lskip_11
    s_mov_b32 s59, 0
    s_nop 1
Lloop_12:
    s_sleep 4
    buffer_load_dword v27, v26, s[48:51], s36 offen sc1
    s_add_u32 s59, s59, 1
    s_waitcnt vmcnt(0)
    v_cmp_ne_u32 vcc, s55, v27
    s_nop 0
    s_and_b32 s61, vcc_lo, s60
    s_cselect_b32 s61, s59, 0x40000
    s_cmp_lt_u32 s61, 0x40000
    s_cbranch_scc1 Lloop_12
Lskip_11:
    s_lshl_b32 s58, s73, 7
    s_lshl_b32 s59, s52, 11
    s_add_u32 s58, s58, s59
    s_add_u32 m0, s58, 154496
    s_add_u32 s58, s37, 4325376
    buffer_load_dwordx4 v5, s[48:51], s58 offen offset:0 sc1 lds
    buffer_load_dwordx4 v5, s[48:51], s58 offen offset:1024 sc1 lds
    s_lshl_b32 s42, s52, 11
    s_add_u32 s43, s42, s78
    s_add_u32 s43, s43, 2228224
    buffer_load_dwordx4 a[200:203], v5, s[48:51], s80 offen offset:1024 sc1
    buffer_load_dwordx4 a[208:211], v5, s[48:51], s80 offen offset:2048 sc1
    buffer_load_dwordx4 a[216:219], v5, s[48:51], s80 offen offset:3072 sc1
    s_mov_b32 s60, -1
    v_cmp_ne_u32 vcc, s55, v25
    s_nop 0
    s_and_b32 s61, vcc_lo, s60
    s_cbranch_scc0 Lskip_13
    s_mov_b32 s59, 0
    s_nop 1
Lloop_14:
    s_sleep 4
    buffer_load_dword v25, v1, s[48:51], s27 offen sc1
    s_add_u32 s59, s59, 1
    s_waitcnt vmcnt(0)
    v_cmp_ne_u32 vcc, s55, v25
    s_nop 0
    s_and_b32 s61, vcc_lo, s60
    s_cselect_b32 s61, s59, 0x40000
    s_cmp_lt_u32 s61, 0x40000
    s_cbranch_scc1 Lloop_14
Lskip_13:
    s_add_u32 s80, s80, 4096
    buffer_load_dwordx4 a[4:7], v5, s[48:51], s80 offen offset:0 sc1
    buffer_load_dwordx4 a[12:15], v5, s[48:51], s80 offen offset:1024 sc1
    buffer_load_dwordx4 a[20:23], v5, s[48:51], s80 offen offset:2048 sc1
    buffer_load_dwordx4 a[28:31], v5, s[48:51], s80 offen offset:3072 sc1
    s_waitcnt vmcnt(9)
    s_mov_b64 exec, 1
    s_cmp_eq_u32 s84, 0
    s_cbranch_scc1 Lfa_15
    buffer_store_dword v19, off, s[48:51], s75 offset:128 sc1
    s_branch Lfb_16
Lfa_15:
    buffer_store_dword v19, off, s[48:51], s75 offset:128
Lfb_16:
    s_mov_b64 exec, -1
    s_add_u32 s80, s80, 4096
    buffer_load_dwordx4 a[36:39], v5, s[48:51], s80 offen offset:0 sc1
    s_waitcnt vmcnt(9)
    s_barrier
    ds_read_b128 v[64:67], v23 offset:0
    buffer_load_dwordx4 a[44:47], v5, s[48:51], s80 offen offset:1024 sc1
    ds_read_b64 v[80:81], v24 offset:3584
    ds_read_b64 v[82:83], v24 offset:3592
    ds_read_b128 v[68:71], v23 offset:512
    ds_read_b64 v[84:85], v24 offset:3072
    ds_read_b64 v[86:87], v24 offset:3080
    ds_read_b128 v[72:75], v23 offset:1024
    ds_read_b64 v[88:89], v24 offset:2560
    ds_read_b64 v[90:91], v24 offset:2568
    ds_read_b128 v[76:79], v23 offset:1536
    ds_read_b64 v[92:93], v24 offset:2048
    ds_read_b64 v[94:95], v24 offset:2056
    s_waitcnt lgkmcnt(9)
    v_mfma_f32_16x16x32_bf16 v[160:163], v[64:67], v[80:83], 0
    buffer_load_dwordx4 a[52:55], v5, s[48:51], s80 offen offset:2048 sc1
    ds_read_b128 v[128:131], v23 offset:2048
    s_waitcnt lgkmcnt(7)
    v_mfma_f32_16x16x32_bf16 v[164:167], v[64:67], v[84:87], 0
    ds_read_b64 v[144:145], v24 offset:1536
    v_mfma_f32_16x16x32_bf16 v[168:171], v[68:71], v[84:87], 0
    buffer_load_dwordx4 a[60:63], v5, s[48:51], s80 offen offset:3072 sc1
    ds_read_b64 v[146:147], v24 offset:1544
    v_mfma_f32_16x16x32_bf16 v[164:167], v[68:71], v[80:83], v[164:167]
    s_add_u32 s27, s74, 128
    buffer_load_dword v1, v18, s[48:51], s27 offen sc1
    ds_read_b128 v[132:135], v23 offset:2560
    s_waitcnt lgkmcnt(7)
    v_mfma_f32_16x16x32_bf16 v[168:171], v[64:67], v[88:91], v[168:171]
    ds_read_b64 v[148:149], v24 offset:1024
    ds_read_b64 v[150:151], v24 offset:1032
    v_mfma_f32_16x16x32_bf16 v[172:175], v[68:71], v[88:91], 0
    ds_read_b128 v[136:139], v23 offset:3072
    v_mfma_f32_16x16x32_bf16 v[176:179], v[72:75], v[88:91], 0
    s_add_u32 s80, s80, 4096
    buffer_load_dwordx4 a[68:71], v5, s[48:51], s80 offen offset:0 sc1
    ds_read_b64 v[152:153], v24 offset:512
    v_mfma_f32_16x16x32_bf16 v[168:171], v[72:75], v[80:83], v[168:171]
    ds_read_b64 v[154:155], v24 offset:520
    v_mfma_f32_16x16x32_bf16 v[172:175], v[72:75], v[84:87], v[172:175]
    ds_read_b128 v[140:143], v23 offset:3584
    s_waitcnt lgkmcnt(10)
    v_mfma_f32_16x16x32_bf16 v[172:175], v[64:67], v[92:95], v[172:175]
    buffer_load_dwordx4 a[76:79], v5, s[48:51], s80 offen offset:1024 sc1
    ds_read_b64 v[156:157], v24 offset:0
    ds_read_b64 v[158:159], v24 offset:8
    v_mfma_f32_16x16x32_bf16 v[176:179], v[68:71], v[92:95], v[176:179]
    v_mfma_f32_16x16x32_bf16 v[180:183], v[72:75], v[92:95], 0
    v_mfma_f32_16x16x32_bf16 v[184:187], v[76:79], v[92:95], 0
    v_mfma_f32_16x16x32_bf16 v[172:175], v[76:79], v[80:83], v[172:175]
    buffer_load_dwordx4 a[84:87], v5, s[48:51], s80 offen offset:2048 sc1
    v_mfma_f32_16x16x32_bf16 v[176:179], v[76:79], v[84:87], v[176:179]
    v_mfma_f32_16x16x32_bf16 v[180:183], v[76:79], v[88:91], v[180:183]
    s_waitcnt lgkmcnt(6)
    v_mfma_f32_16x16x32_bf16 v[176:179], v[64:67], v[144:147], v[176:179]
    v_mfma_f32_16x16x32_bf16 v[180:183], v[68:71], v[144:147], v[180:183]
    buffer_load_dwordx4 a[92:95], v5, s[48:51], s80 offen offset:3072 sc1
    buffer_load_dword v25, v18, s[48:51], s27 offen sc1
    ds_read_b128 v[96:99], v23 offset:64
    v_mfma_f32_16x16x32_bf16 v[184:187], v[72:75], v[144:147], v[184:187]
    ds_read_b64 v[112:113], v24 offset:3648
    v_mfma_f32_16x16x32_bf16 v[188:191], v[76:79], v[144:147], 0
    ds_read_b64 v[114:115], v24 offset:3656
    v_mfma_f32_16x16x32_bf16 v[176:179], v[128:131], v[80:83], v[176:179]
    ds_read_b128 v[100:103], v23 offset:576
    v_mfma_f32_16x16x32_bf16 v[180:183], v[128:131], v[84:87], v[180:183]
    s_add_u32 s80, s80, 4096
    buffer_load_dwordx4 a[100:103], v5, s[48:51], s80 offen offset:0 sc1
    ds_read_b64 v[116:117], v24 offset:3136
    v_mfma_f32_16x16x32_bf16 v[184:187], v[128:131], v[88:91], v[184:187]
    ds_read_b64 v[118:119], v24 offset:3144
    v_mfma_f32_16x16x32_bf16 v[188:191], v[128:131], v[92:95], v[188:191]
    v_mfma_f32_16x16x32_bf16 v[180:183], v[64:67], v[148:151], v[180:183]
    ds_read_b128 v[104:107], v23 offset:1088
    v_mfma_f32_16x16x32_bf16 v[184:187], v[68:71], v[148:151], v[184:187]
    ds_read_b64 v[120:121], v24 offset:2624
    v_mfma_f32_16x16x32_bf16 v[188:191], v[72:75], v[148:151], v[188:191]
    ds_read_b64 v[122:123], v24 offset:2632
    v_mfma_f32_16x16x32_bf16 v[180:183], v[132:135], v[80:83], v[180:183]
    ds_read_b128 v[108:111], v23 offset:1600
    v_mfma_f32_16x16x32_bf16 v[184:187], v[132:135], v[84:87], v[184:187]
    ds_read_b64 v[124:125], v24 offset:2112
    v_mfma_f32_16x16x32_bf16 v[188:191], v[132:135], v[88:91], v[188:191]
    ds_read_b64 v[126:127], v24 offset:2120
    s_waitcnt lgkmcnt(12)
    v_mfma_f32_16x16x32_bf16 v[184:187], v[64:67], v[152:155], v[184:187]
    v_mfma_f32_16x16x32_bf16 v[188:191], v[68:71], v[152:155], v[188:191]
    buffer_load_dword v32, v18, s[48:51], s27 offen sc1
    v_mfma_f32_16x16x32_bf16 v[184:187], v[136:139], v[80:83], v[184:187]
    v_mfma_f32_16x16x32_bf16 v[188:191], v[136:139], v[84:87], v[188:191]
    buffer_load_dwordx4 a[108:111], v5, s[48:51], s80 offen offset:1024 sc1
    v_mfma_f32_16x16x32_bf16 v[188:191], v[64:67], v[156:159], v[188:191]
    v_mfma_f32_16x16x32_bf16 v[188:191], v[140:143], v[80:83], v[188:191]
    s_waitcnt lgkmcnt(6)
    v_mfma_f32_16x16x32_bf16 v[160:163], v[96:99], v[112:115], v[160:163]
    ds_read_b128 v[128:131], v23 offset:2112
    v_mfma_f32_16x16x32_bf16 v[164:167], v[96:99], v[116:119], v[164:167]
    ds_read_b64 v[144:145], v24 offset:1600
    v_mfma_f32_16x16x32_bf16 v[168:171], v[100:103], v[116:119], v[168:171]
    ds_read_b64 v[146:147], v24 offset:1608
    v_mfma_f32_16x16x32_bf16 v[164:167], v[100:103], v[112:115], v[164:167]
    ds_read_b128 v[132:135], v23 offset:2624
    s_waitcnt lgkmcnt(4)
    v_mfma_f32_16x16x32_bf16 v[168:171], v[96:99], v[120:123], v[168:171]
    buffer_load_dwordx4 a[116:119], v5, s[48:51], s80 offen offset:2048 sc1
    ds_read_b64 v[148:149], v24 offset:1088
    ds_read_b64 v[150:151], v24 offset:1096
    v_mfma_f32_16x16x32_bf16 v[172:175], v[100:103], v[120:123], v[172:175]
    ds_read_b128 v[136:139], v23 offset:3136
    v_mfma_f32_16x16x32_bf16 v[176:179], v[104:107], v[120:123], v[176:179]
    ds_read_b64 v[152:153], v24 offset:576
    v_mfma_f32_16x16x32_bf16 v[168:171], v[104:107], v[112:115], v[168:171]
    ds_read_b64 v[154:155], v24 offset:584
    v_mfma_f32_16x16x32_bf16 v[172:175], v[104:107], v[116:119], v[172:175]
    buffer_load_dwordx4 a[124:127], v5, s[48:51], s80 offen offset:3072 sc1
    ds_read_b128 v[140:143], v23 offset:3648
    v_mfma_f32_16x16x32_bf16 v[172:175], v[96:99], v[124:127], v[172:175]
    ds_read_b64 v[156:157], v24 offset:64
    ds_read_b64 v[158:159], v24 offset:72
    v_mfma_f32_16x16x32_bf16 v[176:179], v[100:103], v[124:127], v[176:179]
    s_mov_b32 s60, 0xfffffff
    s_waitcnt vmcnt(10)
    v_cmp_ne_u32 vcc, s55, v1
    s_nop 0
    s_and_b32 s61, vcc_lo, s60
    s_cbranch_scc0 Lskip_17
    s_waitcnt vmcnt(5)
    v_cmp_ne_u32 vcc, s55, v25
    s_nop 0
    s_and_b32 s61, vcc_lo, s60
    s_cbranch_scc0 Lskip_18
    s_waitcnt vmcnt(3)
    v_cmp_ne_u32 vcc, s55, v32
    s_nop 0
    s_and_b32 s61, vcc_lo, s60
    s_cbranch_scc0 Lskip_19
    s_mov_b32 s59, 0
    s_nop 1
Lloop_20:
    buffer_load_dword v1, v18, s[48:51], s27 offen sc1
    s_add_u32 s59, s59, 1
    s_waitcnt vmcnt(0)
    v_cmp_ne_u32 vcc, s55, v1
    s_nop 0
    s_and_b32 s61, vcc_lo, s60
    s_cselect_b32 s61, s59, 0x40000
    s_cmp_lt_u32 s61, 0x40000
    s_cbranch_scc1 Lloop_20
Lskip_19:
Lskip_18:
Lskip_17:
    v_mfma_f32_16x16x32_bf16 v[180:183], v[104:107], v[124:127], v[180:183]
    s_add_u32 m0, s42, 0
    s_add_u32 s62, s43, 0
    buffer_load_dwordx4 v5, s[48:51], s62 offen offset:0 sc1 lds
    v_mfma_f32_16x16x32_bf16 v[184:187], v[108:111], v[124:127], v[184:187]
    v_mfma_f32_16x16x32_bf16 v[172:175], v[108:111], v[112:115], v[172:175]
    s_add_u32 m0, s42, 8192
    s_add_u32 s62, s43, 8192
    buffer_load_dwordx4 v5, s[48:51], s62 offen offset:0 sc1 lds
    v_mfma_f32_16x16x32_bf16 v[176:179], v[108:111], v[116:119], v[176:179]
    v_mfma_f32_16x16x32_bf16 v[180:183], v[108:111], v[120:123], v[180:183]
    s_waitcnt lgkmcnt(6)
    v_mfma_f32_16x16x32_bf16 v[176:179], v[96:99], v[144:147], v[176:179]
    v_mfma_f32_16x16x32_bf16 v[180:183], v[100:103], v[144:147], v[180:183]
    s_add_u32 m0, s42, 16384
    s_add_u32 s62, s43, 16384
    buffer_load_dwordx4 v5, s[48:51], s62 offen offset:0 sc1 lds
    ds_read_b128 v[64:67], v23 offset:128
    v_mfma_f32_16x16x32_bf16 v[184:187], v[104:107], v[144:147], v[184:187]
    ds_read_b64 v[80:81], v24 offset:3712
    v_mfma_f32_16x16x32_bf16 v[188:191], v[108:111], v[144:147], v[188:191]
    ds_read_b64 v[82:83], v24 offset:3720
    v_mfma_f32_16x16x32_bf16 v[176:179], v[128:131], v[112:115], v[176:179]
    s_add_u32 m0, s42, 24576
    s_add_u32 s62, s43, 24576
    buffer_load_dwordx4 v5, s[48:51], s62 offen offset:0 sc1 lds
    ds_read_b128 v[68:71], v23 offset:640
    v_mfma_f32_16x16x32_bf16 v[180:183], v[128:131], v[116:119], v[180:183]
    ds_read_b64 v[84:85], v24 offset:3200
    v_mfma_f32_16x16x32_bf16 v[184:187], v[128:131], v[120:123], v[184:187]
    ds_read_b64 v[86:87], v24 offset:3208
    v_mfma_f32_16x16x32_bf16 v[188:191], v[128:131], v[124:127], v[188:191]
    v_mfma_f32_16x16x32_bf16 v[180:183], v[96:99], v[148:151], v[180:183]
    s_add_u32 m0, s42, 32768
    s_add_u32 s62, s43, 32768
    buffer_load_dwordx4 v5, s[48:51], s62 offen offset:0 sc1 lds
    ds_read_b128 v[72:75], v23 offset:1152
    v_mfma_f32_16x16x32_bf16 v[184:187], v[100:103], v[148:151], v[184:187]
    ds_read_b64 v[88:89], v24 offset:2688
    v_mfma_f32_16x16x32_bf16 v[188:191], v[104:107], v[148:151], v[188:191]
    ds_read_b64 v[90:91], v24 offset:2696
    v_mfma_f32_16x16x32_bf16 v[180:183], v[132:135], v[112:115], v[180:183]
    ds_read_b128 v[76:79], v23 offset:1664
    v_mfma_f32_16x16x32_bf16 v[184:187], v[132:135], v[116:119], v[184:187]
    ds_read_b64 v[92:93], v24 offset:2176
    v_mfma_f32_16x16x32_bf16 v[188:191], v[132:135], v[120:123], v[188:191]
    ds_read_b64 v[94:95], v24 offset:2184
    s_waitcnt lgkmcnt(12)
    v_mfma_f32_16x16x32_bf16 v[184:187], v[96:99], v[152:155], v[184:187]
    v_mfma_f32_16x16x32_bf16 v[188:191], v[100:103], v[152:155], v[188:191]
    v_mfma_f32_16x16x32_bf16 v[184:187], v[136:139], v[112:115], v[184:187]
    v_mfma_f32_16x16x32_bf16 v[188:191], v[136:139], v[116:119], v[188:191]
    v_mfma_f32_16x16x32_bf16 v[188:191], v[96:99], v[156:159], v[188:191]
    v_mfma_f32_16x16x32_bf16 v[188:191], v[140:143], v[112:115], v[188:191]
    s_add_u32 m0, s42, 40960
    s_add_u32 s62, s43, 40960
    buffer_load_dwordx4 v5, s[48:51], s62 offen offset:0 sc1 lds
    s_waitcnt lgkmcnt(6)
    v_mfma_f32_16x16x32_bf16 v[160:163], v[64:67], v[80:83], v[160:163]
    ds_read_b128 v[128:131], v23 offset:2176
    v_mfma_f32_16x16x32_bf16 v[164:167], v[64:67], v[84:87], v[164:167]
    ds_read_b64 v[144:145], v24 offset:1664
    v_mfma_f32_16x16x32_bf16 v[168:171], v[68:71], v[84:87], v[168:171]
    ds_read_b64 v[146:147], v24 offset:1672
    v_mfma_f32_16x16x32_bf16 v[164:167], v[68:71], v[80:83], v[164:167]
    ds_read_b128 v[132:135], v23 offset:2688
    s_waitcnt lgkmcnt(4)
    v_mfma_f32_16x16x32_bf16 v[168:171], v[64:67], v[88:91], v[168:171]
    ds_read_b64 v[148:149], v24 offset:1152
    ds_read_b64 v[150:151], v24 offset:1160
    v_mfma_f32_16x16x32_bf16 v[172:175], v[68:71], v[88:91], v[172:175]
    s_add_u32 m0, s42, 49152
    s_add_u32 s62, s43, 49152
    buffer_load_dwordx4 v5, s[48:51], s62 offen offset:0 sc1 lds
    ds_read_b128 v[136:139], v23 offset:3200
    v_mfma_f32_16x16x32_bf16 v[176:179], v[72:75], v[88:91], v[176:179]
    ds_read_b64 v[152:153], v24 offset:640
    v_mfma_f32_16x16x32_bf16 v[168:171], v[72:75], v[80:83], v[168:171]
    ds_read_b64 v[154:155], v24 offset:648
    v_mfma_f32_16x16x32_bf16 v[172:175], v[72:75], v[84:87], v[172:175]
    ds_read_b128 v[140:143], v23 offset:3712
    v_mfma_f32_16x16x32_bf16 v[172:175], v[64:67], v[92:95], v[172:175]
    s_add_u32 m0, s42, 57344
    s_lshl_b32 s62, s54, 13
    s_add_u32 s62, s62, s42
    s_add_u32 s62, s62, 4063232
    buffer_load_dwordx4 v5, s[48:51], s62 offen offset:0 sc1 lds
    buffer_load_dwordx4 v5, s[48:51], s62 offen offset:1024 sc1 lds
    ds_read_b64 v[156:157], v24 offset:128
    ds_read_b64 v[158:159], v24 offset:136
    v_mfma_f32_16x16x32_bf16 v[176:179], v[68:71], v[92:95], v[176:179]
    v_mfma_f32_16x16x32_bf16 v[180:183], v[72:75], v[92:95], v[180:183]
    v_mfma_f32_16x16x32_bf16 v[184:187], v[76:79], v[92:95], v[184:187]
    v_mfma_f32_16x16x32_bf16 v[172:175], v[76:79], v[80:83], v[172:175]
    v_mfma_f32_16x16x32_bf16 v[176:179], v[76:79], v[84:87], v[176:179]
    v_mfma_f32_16x16x32_bf16 v[180:183], v[76:79], v[88:91], v[180:183]
    s_add_u32 m0, s42, 0
    s_add_u32 s62, s43, 0
    buffer_load_dwordx4 v5, s[48:51], s62 offen offset:1024 sc1 lds
    s_waitcnt lgkmcnt(6)
    v_mfma_f32_16x16x32_bf16 v[176:179], v[64:67], v[144:147], v[176:179]
    v_mfma_f32_16x16x32_bf16 v[180:183], v[68:71], v[144:147], v[180:183]
    ds_read_b128 v[96:99], v23 offset:192
    v_mfma_f32_16x16x32_bf16 v[184:187], v[72:75], v[144:147], v[184:187]
    s_add_u32 m0, s42, 8192
    s_add_u32 s62, s43, 8192
    buffer_load_dwordx4 v5, s[48:51], s62 offen offset:1024 sc1 lds
    ds_read_b64 v[112:113], v24 offset:3776
    v_mfma_f32_16x16x32_bf16 v[188:191], v[76:79], v[144:147], v[188:191]
    ds_read_b64 v[114:115], v24 offset:3784
    v_mfma_f32_16x16x32_bf16 v[176:179], v[128:131], v[80:83], v[176:179]
    ds_read_b128 v[100:103], v23 offset:704
    v_mfma_f32_16x16x32_bf16 v[180:183], v[128:131], v[84:87], v[180:183]
    ds_read_b64 v[116:117], v24 offset:3264
    v_mfma_f32_16x16x32_bf16 v[184:187], v[128:131], v[88:91], v[184:187]
    s_add_u32 m0, s42, 16384
    s_add_u32 s62, s43, 16384
    buffer_load_dwordx4 v5, s[48:51], s62 offen offset:1024 sc1 lds
    ds_read_b64 v[118:119], v24 offset:3272
    v_mfma_f32_16x16x32_bf16 v[188:191], v[128:131], v[92:95], v[188:191]
    v_mfma_f32_16x16x32_bf16 v[180:183], v[64:67], v[148:151], v[180:183]
    ds_read_b128 v[104:107], v23 offset:1216
    v_mfma_f32_16x16x32_bf16 v[184:187], v[68:71], v[148:151], v[184:187]
    s_add_u32 m0, s42, 24576
    s_add_u32 s62, s43, 24576
    buffer_load_dwordx4 v5, s[48:51], s62 offen offset:1024 sc1 lds
    ds_read_b64 v[120:121], v24 offset:2752
    v_mfma_f32_16x16x32_bf16 v[188:191], v[72:75], v[148:151], v[188:191]
    ds_read_b64 v[122:123], v24 offset:2760
    v_mfma_f32_16x16x32_bf16 v[180:183], v[132:135], v[80:83], v[180:183]
    ds_read_b128 v[108:111], v23 offset:1728
    v_mfma_f32_16x16x32_bf16 v[184:187], v[132:135], v[84:87], v[184:187]
    ds_read_b64 v[124:125], v24 offset:2240
    v_mfma_f32_16x16x32_bf16 v[188:191], v[132:135], v[88:91], v[188:191]
    ds_read_b64 v[126:127], v24 offset:2248
    s_waitcnt lgkmcnt(12)
    v_mfma_f32_16x16x32_bf16 v[184:187], v[64:67], v[152:155], v[184:187]
    v_mfma_f32_16x16x32_bf16 v[188:191], v[68:71], v[152:155], v[188:191]
    v_mfma_f32_16x16x32_bf16 v[184:187], v[136:139], v[80:83], v[184:187]
    v_mfma_f32_16x16x32_bf16 v[188:191], v[136:139], v[84:87], v[188:191]
    v_mfma_f32_16x16x32_bf16 v[188:191], v[64:67], v[156:159], v[188:191]
    v_mfma_f32_16x16x32_bf16 v[188:191], v[140:143], v[80:83], v[188:191]
    s_waitcnt lgkmcnt(6)
    v_mfma_f32_16x16x32_bf16 v[160:163], v[96:99], v[112:115], v[160:163]
    s_add_u32 m0, s42, 32768
    s_add_u32 s62, s43, 32768
    buffer_load_dwordx4 v5, s[48:51], s62 offen offset:1024 sc1 lds
    ds_read_b128 v[128:131], v23 offset:2240
    v_mfma_f32_16x16x32_bf16 v[164:167], v[96:99], v[116:119], v[164:167]
    ds_read_b64 v[144:145], v24 offset:1728
    v_mfma_f32_16x16x32_bf16 v[168:171], v[100:103], v[116:119], v[168:171]
    ds_read_b64 v[146:147], v24 offset:1736
    v_mfma_f32_16x16x32_bf16 v[164:167], v[100:103], v[112:115], v[164:167]
    ds_read_b128 v[132:135], v23 offset:2752
    s_waitcnt lgkmcnt(4)
    v_mfma_f32_16x16x32_bf16 v[168:171], v[96:99], v[120:123], v[168:171]
    ds_read_b64 v[148:149], v24 offset:1216
    ds_read_b64 v[150:151], v24 offset:1224
    v_mfma_f32_16x16x32_bf16 v[172:175], v[100:103], v[120:123], v[172:175]
    ds_read_b128 v[136:139], v23 offset:3264
    v_mfma_f32_16x16x32_bf16 v[176:179], v[104:107], v[120:123], v[176:179]
    s_add_u32 m0, s42, 40960
    s_add_u32 s62, s43, 40960
    buffer_load_dwordx4 v5, s[48:51], s62 offen offset:1024 sc1 lds
    ds_read_b64 v[152:153], v24 offset:704
    v_mfma_f32_16x16x32_bf16 v[168:171], v[104:107], v[112:115], v[168:171]
    ds_read_b64 v[154:155], v24 offset:712
    v_mfma_f32_16x16x32_bf16 v[172:175], v[104:107], v[116:119], v[172:175]
    ds_read_b128 v[140:143], v23 offset:3776
    v_mfma_f32_16x16x32_bf16 v[172:175], v[96:99], v[124:127], v[172:175]
    ds_read_b64 v[156:157], v24 offset:192
    ds_read_b64 v[158:159], v24 offset:200
    v_mfma_f32_16x16x32_bf16 v[176:179], v[100:103], v[124:127], v[176:179]
    s_add_u32 m0, s42, 49152
    s_add_u32 s62, s43, 49152
    buffer_load_dwordx4 v5, s[48:51], s62 offen offset:1024 sc1 lds
    v_mfma_f32_16x16x32_bf16 v[180:183], v[104:107], v[124:127], v[180:183]
    v_mfma_f32_16x16x32_bf16 v[184:187], v[108:111], v[124:127], v[184:187]
    v_mfma_f32_16x16x32_bf16 v[172:175], v[108:111], v[112:115], v[172:175]
    v_mfma_f32_16x16x32_bf16 v[176:179], v[108:111], v[116:119], v[176:179]
    v_mfma_f32_16x16x32_bf16 v[180:183], v[108:111], v[120:123], v[180:183]
    s_add_u32 s80, s80, 4096
    buffer_load_dwordx4 a[132:135], v5, s[48:51], s80 offen offset:0 sc1
    s_waitcnt lgkmcnt(6)
    v_mfma_f32_16x16x32_bf16 v[176:179], v[96:99], v[144:147], v[176:179]
    v_mfma_f32_16x16x32_bf16 v[180:183], v[100:103], v[144:147], v[180:183]
    v_mfma_f32_16x16x32_bf16 v[184:187], v[104:107], v[144:147], v[184:187]
    buffer_load_dwordx4 a[140:143], v5, s[48:51], s80 offen offset:1024 sc1
    v_mfma_f32_16x16x32_bf16 v[188:191], v[108:111], v[144:147], v[188:191]
    v_mfma_f32_16x16x32_bf16 v[176:179], v[128:131], v[112:115], v[176:179]
    v_mfma_f32_16x16x32_bf16 v[180:183], v[128:131], v[116:119], v[180:183]
    v_mfma_f32_16x16x32_bf16 v[184:187], v[128:131], v[120:123], v[184:187]
    buffer_load_dwordx4 a[148:151], v5, s[48:51], s80 offen offset:2048 sc1
    v_mfma_f32_16x16x32_bf16 v[188:191], v[128:131], v[124:127], v[188:191]
    v_mfma_f32_16x16x32_bf16 v[180:183], v[96:99], v[148:151], v[180:183]
    v_mfma_f32_16x16x32_bf16 v[184:187], v[100:103], v[148:151], v[184:187]
    v_mfma_f32_16x16x32_bf16 v[188:191], v[104:107], v[148:151], v[188:191]
    v_mfma_f32_16x16x32_bf16 v[180:183], v[132:135], v[112:115], v[180:183]
    v_min_u32 v1, 3, v0
    v_lshlrev_b32 v1, 7, v1
    s_add_u32 s27, s81, 66560
    buffer_load_dword v33, v1, s[48:51], s27 offen sc1
    buffer_load_dwordx4 a[156:159], v5, s[48:51], s80 offen offset:3072 sc1
    v_mfma_f32_16x16x32_bf16 v[184:187], v[132:135], v[116:119], v[184:187]
    v_mfma_f32_16x16x32_bf16 v[188:191], v[132:135], v[120:123], v[188:191]
    s_add_u32 s80, s80, 4096
    buffer_load_dwordx4 a[164:167], v5, s[48:51], s80 offen offset:0 sc1
    s_waitcnt lgkmcnt(0)
    v_mfma_f32_16x16x32_bf16 v[184:187], v[96:99], v[152:155], v[184:187]
    v_mfma_f32_16x16x32_bf16 v[188:191], v[100:103], v[152:155], v[188:191]
    v_mfma_f32_16x16x32_bf16 v[184:187], v[136:139], v[112:115], v[184:187]
    v_mfma_f32_16x16x32_bf16 v[188:191], v[136:139], v[116:119], v[188:191]
    v_mfma_f32_16x16x32_bf16 v[188:191], v[96:99], v[156:159], v[188:191]
    v_mfma_f32_16x16x32_bf16 v[188:191], v[140:143], v[112:115], v[188:191]
    s_lshl_b32 s56, s52, 13
    s_add_u32 s56, s56, 118400
    v_add_u32 v23, s56, v5
    s_lshl_b32 s36, s53, 14
    s_add_u32 s36, s36, s79
    s_waitcnt vmcnt(13)
    s_barrier
    ds_read_b128 v[104:107], v5 offset:0
    ds_read_b128 v[108:111], v5 offset:2048
    ds_read_b128 v[112:115], v5 offset:4096
    ds_read_b128 v[116:119], v5 offset:6144
    ds_read_b128 v[120:123], v5 offset:8192
    s_waitcnt lgkmcnt(4)
    v_mfma_f32_32x32x16_bf16 v[88:103], a[0:3], v[104:107], 0
    buffer_load_dwordx4 a[172:175], v5, s[48:51], s80 offen offset:1024 sc1
    ds_read_b128 v[124:127], v5 offset:10240
    s_waitcnt lgkmcnt(4)
    v_mfma_f32_32x32x16_bf16 v[88:103], a[8:11], v[108:111], v[88:103]
    buffer_load_dwordx4 a[180:183], v5, s[48:51], s80 offen offset:2048 sc1
    ds_read_b128 v[104:107], v5 offset:12288
    ds_write_b128 v23, v[160:163] offset:0
    ds_read2st64_b32 v[128:129], v22 offset0:224 offset1:225
    ds_read2st64_b32 v[130:131], v22 offset0:226 offset1:227
    s_lshl_b32 s56, s52, 10
    s_sub_u32 s56, 158072, s56
    v_lshlrev_b32 v3, 1, v22
    v_sub_u32 v3, s56, v3
    s_waitcnt lgkmcnt(6)
    v_mfma_f32_32x32x16_bf16 v[88:103], a[16:19], v[112:115], v[88:103]
    ds_read_b128 v[108:111], v5 offset:14336
    ds_write_b128 v23, v[164:167] offset:1024
    ds_read2st64_b32 v[132:133], v22 offset0:228 offset1:229
    ds_read2st64_b32 v[134:135], v22 offset0:230 offset1:231
    s_lshl_b32 s56, s52, 11
    s_add_u32 s56, s56, 118400
    v_add_u32 v24, s56, v5
    v_mfma_f32_32x32x16_bf16 v[88:103], a[24:27], v[116:119], v[88:103]
    buffer_load_dwordx4 a[188:191], v5, s[48:51], s80 offen offset:3072 sc1
    ds_read_b128 v[112:115], v5 offset:16384
    ds_read2st64_b32 v[136:137], v22 offset0:232 offset1:233
    ds_read2st64_b32 v[138:139], v22 offset0:234 offset1:235
    s_waitcnt lgkmcnt(11)
    v_mfma_f32_32x32x16_bf16 v[88:103], a[32:35], v[120:123], v[88:103]
    s_add_u32 s80, s80, 4096
    buffer_load_dwordx4 a[196:199], v5, s[48:51], s80 offen offset:0 sc1
    ds_read_b128 v[116:119], v5 offset:18432
    ds_write_b128 v23, v[168:171] offset:2048
    ds_read2st64_b32 v[140:141], v22 offset0:236 offset1:237
    ds_read2st64_b32 v[142:143], v22 offset0:238 offset1:239
    s_lshl_b32 s66, s26, 16
    s_and_b32 s67, s26, 0xffff0000
    ds_read_b64 v[42:43], v3 offset:512
    v_mfma_f32_32x32x16_bf16 v[88:103], a[40:43], v[124:127], v[88:103]
    buffer_load_dwordx4 a[204:207], v5, s[48:51], s80 offen offset:1024 sc1
    ds_read_b128 v[120:123], v5 offset:20480
    ds_write_b128 v23, v[172:175] offset:3072
    ds_read2st64_b32 v[144:145], v22 offset0:240 offset1:241
    ds_read2st64_b32 v[146:147], v22 offset0:242 offset1:243
    ds_read_b64 v[44:45], v3 offset:0
    ds_read_b64 v[46:47], v3 offset:4736
    ds_read_b64 v[48:49], v3 offset:4224
    s_waitcnt lgkmcnt(15)
    v_mfma_f32_32x32x16_bf16 v[88:103], a[48:51], v[104:107], v[88:103]
    buffer_load_dwordx4 a[212:215], v5, s[48:51], s80 offen offset:2048 sc1
    ds_read_b128 v[124:127], v5 offset:22528
    ds_write_b128 v23, v[176:179] offset:4096
    ds_read2st64_b32 v[148:149], v22 offset0:244 offset1:245
    ds_read2st64_b32 v[150:151], v22 offset0:246 offset1:247
    v_mfma_f32_32x32x16_bf16 v[88:103], a[56:59], v[108:111], v[88:103]
    buffer_load_dwordx4 a[220:223], v5, s[48:51], s80 offen offset:3072 sc1
    ds_read_b128 v[104:107], v5 offset:24576
    ds_read2st64_b32 v[152:153], v22 offset0:248 offset1:249
    ds_read2st64_b32 v[154:155], v22 offset0:250 offset1:251
    v_mov_b32 v52, 0
    v_mov_b32 v53, 0
    v_mov_b32 v56, 0
    s_waitcnt lgkmcnt(15)
    v_mfma_f32_32x32x16_bf16 v[88:103], a[64:67], v[112:115], v[88:103]
    s_mov_b32 s60, -1
    s_waitcnt vmcnt(9)
    v_cmp_ne_u32 vcc, s55, v33
    s_nop 0
    s_and_b32 s61, vcc_lo, s60
    s_cbranch_scc0 Lskip_21
    s_mov_b32 s59, 0
    s_nop 1
Lloop_22:
    s_sleep 4
    buffer_load_dword v33, v1, s[48:51], s27 offen sc1
    s_add_u32 s59, s59, 1
    s_waitcnt vmcnt(0)
    v_cmp_ne_u32 vcc, s55, v33
    s_nop 0
    s_and_b32 s61, vcc_lo, s60
    s_cselect_b32 s61, s59, 0x40000
    s_cmp_lt_u32 s61, 0x40000
    s_cbranch_scc1 Lloop_22
Lskip_21:
    s_add_u32 s80, s80, 4096
    buffer_load_dwordx4 a[224:227], v5, s[48:51], s80 offen offset:0 sc1
    ds_read_b128 v[108:111], v5 offset:26624
    ds_write_b128 v23, v[180:183] offset:5120
    v_mov_b32 v57, 0
    v_mov_b32 v30, 0
    v_mov_b32 v31, 0
    v_mfma_f32_32x32x16_bf16 v[88:103], a[72:75], v[116:119], v[88:103]
    ds_read_b128 v[112:115], v5 offset:28672
    ds_write_b128 v23, v[184:187] offset:6144
    s_waitcnt lgkmcnt(10)
    v_mfma_f32_32x32x16_bf16 v[88:103], a[80:83], v[120:123], v[88:103]
    ds_read_b128 v[116:119], v5 offset:30720
    ds_write_b128 v23, v[188:191] offset:7168
    v_add_f32 v128, v128, v130
    v_add_f32 v129, v129, v131
    v_add_f32 v128, v128, v132
    v_add_f32 v129, v129, v133
    v_add_f32 v128, v128, v134
    v_add_f32 v129, v129, v135
    v_mfma_f32_32x32x16_bf16 v[88:103], a[88:91], v[124:127], v[88:103]
    buffer_load_dwordx4 a[228:231], v5, s[48:51], s80 offen offset:1024 sc1
    ds_read_b128 v[120:123], v5 offset:32768
    v_add_f32 v128, v128, v136
    v_add_f32 v129, v129, v137
    v_add_f32 v128, v128, v138
    v_add_f32 v129, v129, v139
    v_add_f32 v128, v128, v140
    s_waitcnt lgkmcnt(6)
    v_mfma_f32_32x32x16_bf16 v[88:103], a[96:99], v[104:107], v[88:103]
    ds_read_b128 v[124:127], v5 offset:34816
    s_mul_i32 s62, s41, 115712
    s_add_u32 s62, s62, 15450112
    buffer_load_dwordx4 v[26:29], v5, s[48:51], s62 offen sc1
    v_add_f32 v129, v129, v141
    v_add_f32 v128, v128, v129
    v_mov_b32 v129, v128
    s_nop 1
    v_permlane32_swap_b32 v128, v129
    v_mul_f32 v128, 0x3b124925, v128
    s_waitcnt lgkmcnt(2)
    s_barrier
    v_mfma_f32_32x32x16_bf16 v[88:103], a[104:107], v[108:111], v[88:103]
    buffer_load_dwordx4 a[232:235], v5, s[48:51], s80 offen offset:2048 sc1
    ds_read_b128 v[104:107], v5 offset:36864
    ds_read_b128 v[160:163], v24 offset:0
    ds_read_b128 v[164:167], v24 offset:1024
    v_mfma_f32_32x32x16_bf16 v[88:103], a[112:115], v[112:115], v[88:103]
    ds_read_b128 v[108:111], v5 offset:38912
    ds_read_b128 v[168:171], v24 offset:8192
    ds_read_b128 v[172:175], v24 offset:9216
    ds_read_b128 v[176:179], v24 offset:16384
    v_mul_f32 v129, 0x3b124925, v129
    v_fma_f32 v129, -v128, v128, v129
    v_max_f32 v129, 0, v129
    v_add_f32 v129, 0x3727c5ac, v129
    v_rsq_f32 v130, v129
    v_mfma_f32_32x32x16_bf16 v[88:103], a[120:123], v[116:119], v[88:103]
    buffer_load_dwordx4 a[236:239], v5, s[48:51], s80 offen offset:3072 sc1
    ds_read_b128 v[112:115], v5 offset:40960
    ds_read_b128 v[180:183], v24 offset:17408
    ds_read_b128 v[184:187], v24 offset:24576
    ds_read_b128 v[188:191], v24 offset:25600
    v_mul_f32 v128, -0.5, v128
    v_cvt_pk_bf16_f32 v50, v128, v128
    v_lshlrev_b32 v131, 16, v50
    v_sub_f32 v128, v128, v131
    v_cvt_pk_bf16_f32 v51, v128, 0
    s_waitcnt lgkmcnt(11)
    v_mfma_f32_32x32x16_bf16 v[88:103], a[128:131], v[120:123], v[88:103]
    s_add_u32 s80, s80, 4096
    buffer_load_dwordx4 a[240:243], v5, s[48:51], s80 offen offset:0 sc1
    ds_read_b128 v[116:119], v5 offset:43008
    v_mul_f32 v60, v129, v130
    v_mul_f32 v58, 0xc0135761, v130
    v_mul_f32 v59, v130, v130
    v_mul_f32 v59, v59, v130
    v_mul_f32 v59, 0xbdd2d3e8, v59
    v_mfma_f32_32x32x16_bf16 v[88:103], a[136:139], v[124:127], v[88:103]
    ds_read_b128 v[120:123], v5 offset:45056
    v_and_b32 v2, 0xffff0000, v43
    s_waitcnt lgkmcnt(8)
    v_add_f32 v160, v160, v168
    v_fmac_f32 v160, s66, v2
    v_lshlrev_b32 v4, 16, v43
    v_add_f32 v161, v161, v169
    v_fmac_f32 v161, s66, v4
    v_and_b32 v2, 0xffff0000, v42
    v_add_f32 v162, v162, v170
    v_mfma_f32_32x32x16_bf16 v[88:103], a[144:147], v[104:107], v[88:103]
    buffer_load_dwordx4 a[244:247], v5, s[48:51], s80 offen offset:1024 sc1
    ds_read_b128 v[124:127], v5 offset:47104
    v_fmac_f32 v162, s66, v2
    v_lshlrev_b32 v4, 16, v42
    v_add_f32 v163, v163, v171
    v_fmac_f32 v163, s66, v4
    v_and_b32 v2, 0xffff0000, v45
    s_waitcnt lgkmcnt(8)
    v_add_f32 v164, v164, v172
    v_fmac_f32 v164, s66, v2
    v_lshlrev_b32 v4, 16, v45
    v_mfma_f32_32x32x16_bf16 v[88:103], a[152:155], v[108:111], v[88:103]
    buffer_load_dwordx4 a[248:251], v5, s[48:51], s80 offen offset:2048 sc1
    ds_read_b128 v[104:107], v5 offset:49152
    v_add_f32 v165, v165, v173
    v_fmac_f32 v165, s66, v4
    v_and_b32 v2, 0xffff0000, v44
    v_add_f32 v166, v166, v174
    v_fmac_f32 v166, s66, v2
    v_lshlrev_b32 v4, 16, v44
    v_add_f32 v167, v167, v175
    s_waitcnt lgkmcnt(3)
    v_mfma_f32_32x32x16_bf16 v[88:103], a[160:163], v[112:115], v[88:103]
    ds_read_b128 v[108:111], v5 offset:51200
    v_fmac_f32 v167, s66, v4
    v_and_b32 v2, 0xffff0000, v47
    v_add_f32 v176, v176, v184
    v_fmac_f32 v176, s67, v2
    v_lshlrev_b32 v4, 16, v47
    v_add_f32 v177, v177, v185
    v_fmac_f32 v177, s67, v4
    v_and_b32 v2, 0xffff0000, v46
    v_mfma_f32_32x32x16_bf16 v[88:103], a[168:171], v[116:119], v[88:103]
    buffer_load_dwordx4 a[252:255], v5, s[48:51], s80 offen offset:3072 sc1
    ds_read_b128 v[112:115], v5 offset:53248
    v_add_f32 v178, v178, v186
    v_fmac_f32 v178, s67, v2
    v_lshlrev_b32 v4, 16, v46
    v_add_f32 v179, v179, v187
    v_fmac_f32 v179, s67, v4
    v_and_b32 v2, 0xffff0000, v49
    v_add_f32 v180, v180, v188
    v_fmac_f32 v180, s67, v2
    s_waitcnt lgkmcnt(3)
    v_mfma_f32_32x32x16_bf16 v[88:103], a[176:179], v[120:123], v[88:103]
    ds_read_b128 v[116:119], v5 offset:55296
    v_lshlrev_b32 v4, 16, v49
    v_add_f32 v181, v181, v189
    v_fmac_f32 v181, s67, v4
    v_and_b32 v2, 0xffff0000, v48
    v_add_f32 v182, v182, v190
    v_fmac_f32 v182, s67, v2
    v_lshlrev_b32 v4, 16, v48
    v_mfma_f32_32x32x16_bf16 v[88:103], a[184:187], v[124:127], v[88:103]
    ds_read_b128 v[120:123], v5 offset:0
    v_add_f32 v183, v183, v191
    v_fmac_f32 v183, s67, v4
    v_cvt_pk_bf16_f32 v168, v160, v176
    v_cvt_pk_bf16_f32 v169, v161, v177
    v_cvt_pk_bf16_f32 v170, v162, v178
    v_cvt_pk_bf16_f32 v171, v163, v179
    v_cvt_pk_bf16_f32 v172, v164, v180
    v_cvt_pk_bf16_f32 v173, v165, v181
    s_waitcnt lgkmcnt(3)
    v_mfma_f32_32x32x16_bf16 v[88:103], a[192:195], v[104:107], v[88:103]
    s_add_u32 s80, s80, 4096
    s_add_u32 m0, s65, 0
    s_nop 0
    buffer_load_dwordx4 v5, s[48:51], s80 offen offset:0 sc1 lds
    ds_read_b128 v[124:127], v5 offset:2048
    v_cvt_pk_bf16_f32 v174, v166, v182
    v_cvt_pk_bf16_f32 v175, v167, v183
    s_add_u32 s56, s37, 6160384
    buffer_store_dwordx4 v[168:171], v5, s[48:51], s56 offen offset:0 sc1
    buffer_store_dwordx4 v[172:175], v5, s[48:51], s56 offen offset:1024 sc1
    v_mfma_f32_32x32x16_bf16 v[88:103], a[200:203], v[108:111], v[88:103]
    ds_read_b128 v[104:107], v5 offset:4096
    v_add_f32 v142, v142, v144
    v_add_f32 v143, v143, v145
    v_add_f32 v142, v142, v146
    v_add_f32 v143, v143, v147
    v_add_f32 v142, v142, v148
    v_add_f32 v143, v143, v149
    v_add_f32 v142, v142, v150
    v_add_f32 v143, v143, v151
    v_add_f32 v142, v142, v152
    v_add_f32 v143, v143, v153
    v_add_f32 v142, v142, v154
    s_waitcnt lgkmcnt(3)
    v_mfma_f32_32x32x16_bf16 v[88:103], a[208:211], v[112:115], v[88:103]
    ds_read_b128 v[108:111], v5 offset:6144
    v_add_f32 v143, v143, v155
    v_add_f32 v142, v142, v143
    v_mov_b32 v143, v142
    s_nop 1
    v_permlane32_swap_b32 v142, v143
    v_mul_f32 v142, 0x3b124925, v142
    v_mul_f32 v143, 0x3b124925, v143
    v_fma_f32 v143, -v142, v142, v143
    v_max_f32 v143, 0, v143
    v_add_f32 v143, 0x3727c5ac, v143
    v_rsq_f32 v144, v143
    v_mfma_f32_32x32x16_bf16 v[88:103], a[216:219], v[116:119], v[88:103]
    ds_read_b128 v[112:115], v5 offset:8192
    v_mul_f32 v142, -0.5, v142
    v_cvt_pk_bf16_f32 v54, v142, v142
    v_lshlrev_b32 v145, 16, v54
    v_sub_f32 v142, v142, v145
    v_cvt_pk_bf16_f32 v55, v142, 0
    v_mul_f32 v64, v143, v144
    v_mul_f32 v62, 0xc0135761, v144
    v_mul_f32 v63, v144, v144
    v_mul_f32 v63, v63, v144
    v_mul_f32 v63, 0xbdd2d3e8, v63
    s_waitcnt vmcnt(9)
    v_mfma_f32_32x32x16_bf16 v[88:103], v[26:29], v[50:53], v[88:103]
    buffer_load_dwordx4 v5, s[48:51], s80 offen offset:1024 sc1 lds
    s_waitcnt lgkmcnt(3)
    v_mfma_f32_32x32x16_bf16 v[176:191], a[4:7], v[120:123], 0
    ds_read_b128 v[116:119], v5 offset:10240
    v_mfma_f32_32x32x16_bf16 v[176:191], a[12:15], v[124:127], v[176:191]
    buffer_load_dwordx4 v5, s[48:51], s80 offen offset:2048 sc1 lds
    ds_read_b128 v[120:123], v5 offset:12288
    s_waitcnt lgkmcnt(3)
    v_mfma_f32_32x32x16_bf16 v[176:191], a[20:23], v[104:107], v[176:191]
    ds_read_b128 v[124:127], v5 offset:14336
    s_nop 1
    v_mul_f32 v42, v88, v88
    v_mul_f32 v43, v89, v89
    v_mul_f32 v44, v90, v90
    v_mul_f32 v45, v91, v91
    v_mul_f32 v46, v92, v92
    v_mul_f32 v47, v93, v93
    v_mfma_f32_32x32x16_bf16 v[176:191], a[28:31], v[108:111], v[176:191]
    buffer_load_dwordx4 v5, s[48:51], s80 offen offset:3072 sc1 lds
    ds_read_b128 v[104:107], v5 offset:16384
    v_mul_f32 v48, v94, v94
    v_mul_f32 v49, v95, v95
    v_fma_f32 v42, v42, v59, v58
    v_fma_f32 v43, v43, v59, v58
    v_fma_f32 v44, v44, v59, v58
    v_fma_f32 v45, v45, v59, v58
    s_waitcnt lgkmcnt(3)
    v_mfma_f32_32x32x16_bf16 v[176:191], a[36:39], v[112:115], v[176:191]
    s_add_u32 s80, s80, 4096
    s_add_u32 m0, s65, 4096
    s_nop 0
    buffer_load_dwordx4 v5, s[48:51], s80 offen offset:0 sc1 lds
    ds_read_b128 v[108:111], v5 offset:18432
    v_fma_f32 v46, v46, v59, v58
    v_fma_f32 v47, v47, v59, v58
    v_fma_f32 v48, v48, v59, v58
    v_fma_f32 v49, v49, v59, v58
    v_mul_f32 v42, v42, v88
    v_mul_f32 v43, v43, v89
    v_mfma_f32_32x32x16_bf16 v[176:191], a[44:47], v[116:119], v[176:191]
    ds_read_b128 v[112:115], v5 offset:20480
    v_mul_f32 v44, v44, v90
    v_mul_f32 v45, v45, v91
    v_mul_f32 v46, v46, v92
    v_mul_f32 v47, v47, v93
    v_mul_f32 v48, v48, v94
    v_mul_f32 v49, v49, v95
    s_waitcnt lgkmcnt(3)
    v_mfma_f32_32x32x16_bf16 v[176:191], a[52:55], v[120:123], v[176:191]
    buffer_load_dwordx4 v5, s[48:51], s80 offen offset:1024 sc1 lds
    ds_read_b128 v[116:119], v5 offset:22528
    v_exp_f32 v42, v42
    v_exp_f32 v43, v43
    v_exp_f32 v44, v44
    v_mfma_f32_32x32x16_bf16 v[176:191], a[60:63], v[124:127], v[176:191]
    ds_read_b128 v[120:123], v5 offset:24576
    v_exp_f32 v45, v45
    v_exp_f32 v46, v46
    v_exp_f32 v47, v47
    s_waitcnt lgkmcnt(3)
    v_mfma_f32_32x32x16_bf16 v[176:191], a[68:71], v[104:107], v[176:191]
    ds_read_b128 v[124:127], v5 offset:26624
    v_exp_f32 v48, v48
    v_exp_f32 v49, v49
    v_fma_f32 v42, v42, v60, v60
    v_fma_f32 v43, v43, v60, v60
    v_mfma_f32_32x32x16_bf16 v[176:191], a[76:79], v[108:111], v[176:191]
    buffer_load_dwordx4 v5, s[48:51], s80 offen offset:2048 sc1 lds
    ds_read_b128 v[104:107], v5 offset:28672
    v_fma_f32 v44, v44, v60, v60
    v_fma_f32 v45, v45, v60, v60
    v_fma_f32 v46, v46, v60, v60
    v_fma_f32 v47, v47, v60, v60
    v_fma_f32 v48, v48, v60, v60
    v_fma_f32 v49, v49, v60, v60
    s_waitcnt lgkmcnt(3)
    v_mfma_f32_32x32x16_bf16 v[176:191], a[84:87], v[112:115], v[176:191]
    ds_read_b128 v[108:111], v5 offset:30720
    v_rcp_f32 v42, v42
    v_rcp_f32 v43, v43
    v_rcp_f32 v44, v44
    v_mfma_f32_32x32x16_bf16 v[176:191], a[92:95], v[116:119], v[176:191]
    ds_read_b128 v[112:115], v5 offset:32768
    v_rcp_f32 v45, v45
    v_rcp_f32 v46, v46
    v_rcp_f32 v47, v47
    s_waitcnt lgkmcnt(3)
    v_mfma_f32_32x32x16_bf16 v[176:191], a[100:103], v[120:123], v[176:191]
    buffer_load_dwordx4 v5, s[48:51], s80 offen offset:3072 sc1 lds
    ds_read_b128 v[116:119], v5 offset:34816
    v_rcp_f32 v48, v48
    v_rcp_f32 v49, v49
    v_mul_f32 v42, v42, v88
    v_mul_f32 v43, v43, v89
    v_mfma_f32_32x32x16_bf16 v[176:191], a[108:111], v[124:127], v[176:191]
    ds_read_b128 v[120:123], v5 offset:36864
    v_mul_f32 v44, v44, v90
    v_mul_f32 v45, v45, v91
    v_mul_f32 v46, v46, v92
    v_mul_f32 v47, v47, v93
    v_mul_f32 v48, v48, v94
    v_mul_f32 v49, v49, v95
    s_waitcnt lgkmcnt(3)
    v_mfma_f32_32x32x16_bf16 v[176:191], a[116:119], v[104:107], v[176:191]
    ds_read_b128 v[124:127], v5 offset:38912
    v_cvt_pk_bf16_f32 v128, v42, v43
    v_cvt_pk_bf16_f32 v129, v44, v45
    v_cvt_pk_bf16_f32 v130, v46, v47
    v_cvt_pk_bf16_f32 v131, v48, v49
    buffer_store_dwordx4 v[128:131], v5, s[48:51], s36 offen offset:0 sc1
    v_mfma_f32_32x32x16_bf16 v[176:191], a[124:127], v[108:111], v[176:191]
    ds_read_b128 v[104:107], v5 offset:40960
    v_mul_f32 v42, v96, v96
    v_mul_f32 v43, v97, v97
    v_mul_f32 v44, v98, v98
    v_mul_f32 v45, v99, v99
    v_mul_f32 v46, v100, v100
    v_mul_f32 v47, v101, v101
    s_waitcnt lgkmcnt(3)
    v_mfma_f32_32x32x16_bf16 v[176:191], a[132:135], v[112:115], v[176:191]
    ds_read_b128 v[108:111], v5 offset:43008
    v_mul_f32 v48, v102, v102
    v_mul_f32 v49, v103, v103
    v_fma_f32 v42, v42, v59, v58
    v_fma_f32 v43, v43, v59, v58
    v_fma_f32 v44, v44, v59, v58
    v_fma_f32 v45, v45, v59, v58
    v_mfma_f32_32x32x16_bf16 v[176:191], a[140:143], v[116:119], v[176:191]
    ds_read_b128 v[112:115], v5 offset:45056
    v_fma_f32 v46, v46, v59, v58
    v_fma_f32 v47, v47, v59, v58
    v_fma_f32 v48, v48, v59, v58
    v_fma_f32 v49, v49, v59, v58
    v_mul_f32 v42, v42, v96
    v_mul_f32 v43, v43, v97
    s_add_u32 s61, s76, 262144
    s_waitcnt vmcnt(8)
    buffer_store_dword v19, v18, s[48:51], s61 offen sc1
    s_waitcnt lgkmcnt(3)
    v_mfma_f32_32x32x16_bf16 v[176:191], a[148:151], v[120:123], v[176:191]
    s_add_u32 s80, s80, 4096
    s_add_u32 m0, s65, 8192
    s_nop 0
    buffer_load_dwordx4 v5, s[48:51], s80 offen offset:0 sc1 lds
    ds_read_b128 v[116:119], v5 offset:47104
    v_mul_f32 v44, v44, v98
    v_mul_f32 v45, v45, v99
    v_mul_f32 v46, v46, v100
    v_mul_f32 v47, v47, v101
    v_mul_f32 v48, v48, v102
    v_mul_f32 v49, v49, v103
    v_mfma_f32_32x32x16_bf16 v[176:191], a[156:159], v[124:127], v[176:191]
    buffer_load_dwordx4 v5, s[48:51], s80 offen offset:1024 sc1 lds
    ds_read_b128 v[120:123], v5 offset:49152
    v_exp_f32 v42, v42
    v_exp_f32 v43, v43
    v_exp_f32 v44, v44
    s_waitcnt lgkmcnt(3)
    v_mfma_f32_32x32x16_bf16 v[176:191], a[164:167], v[104:107], v[176:191]
    ds_read_b128 v[124:127], v5 offset:51200
    v_exp_f32 v45, v45
    v_exp_f32 v46, v46
    v_exp_f32 v47, v47
    v_mfma_f32_32x32x16_bf16 v[176:191], a[172:175], v[108:111], v[176:191]
    buffer_load_dwordx4 v5, s[48:51], s80 offen offset:2048 sc1 lds
    ds_read_b128 v[104:107], v5 offset:53248
    v_exp_f32 v48, v48
    v_exp_f32 v49, v49
    v_fma_f32 v42, v42, v60, v60
    v_fma_f32 v43, v43, v60, v60
    s_barrier
    s_waitcnt lgkmcnt(3)
    v_mfma_f32_32x32x16_bf16 v[176:191], a[180:183], v[112:115], v[176:191]
    buffer_load_dwordx4 v5, s[48:51], s80 offen offset:3072 sc1 lds
    ds_read_b128 v[108:111], v5 offset:55296
    v_fma_f32 v44, v44, v60, v60
    v_fma_f32 v45, v45, v60, v60
    v_fma_f32 v46, v46, v60, v60
    v_fma_f32 v47, v47, v60, v60
    v_fma_f32 v48, v48, v60, v60
    v_fma_f32 v49, v49, v60, v60
    v_mfma_f32_32x32x16_bf16 v[176:191], a[188:191], v[116:119], v[176:191]
    s_add_u32 s80, s80, 4096
    buffer_load_dwordx4 v[192:195], v5, s[48:51], s80 offen offset:0 sc1
    ds_read_b128 v[112:115], v5 offset:1024
    v_rcp_f32 v42, v42
    v_rcp_f32 v43, v43
    v_rcp_f32 v44, v44
    s_waitcnt lgkmcnt(3)
    v_mfma_f32_32x32x16_bf16 v[176:191], a[196:199], v[120:123], v[176:191]
    ds_read_b128 v[116:119], v5 offset:3072
    v_rcp_f32 v45, v45
    v_rcp_f32 v46, v46
    v_rcp_f32 v47, v47
    v_mfma_f32_32x32x16_bf16 v[176:191], a[204:207], v[124:127], v[176:191]
    buffer_load_dwordx4 v[196:199], v5, s[48:51], s80 offen offset:1024 sc1
    ds_read_b128 v[120:123], v5 offset:5120
    v_rcp_f32 v48, v48
    v_rcp_f32 v49, v49
    v_mul_f32 v42, v42, v96
    v_mul_f32 v43, v43, v97
    s_waitcnt lgkmcnt(3)
    v_mfma_f32_32x32x16_bf16 v[176:191], a[212:215], v[104:107], v[176:191]
    ds_read_b128 v[124:127], v5 offset:7168
    v_mul_f32 v44, v44, v98
    v_mul_f32 v45, v45, v99
    v_mul_f32 v46, v46, v100
    v_mul_f32 v47, v47, v101
    v_mul_f32 v48, v48, v102
    v_mul_f32 v49, v49, v103
    v_mfma_f32_32x32x16_bf16 v[176:191], a[220:223], v[108:111], v[176:191]
    buffer_load_dwordx4 v[200:203], v5, s[48:51], s80 offen offset:2048 sc1
    ds_read_b128 v[104:107], v5 offset:9216
    v_cvt_pk_bf16_f32 v132, v42, v43
    v_cvt_pk_bf16_f32 v133, v44, v45
    v_cvt_pk_bf16_f32 v134, v46, v47
    v_cvt_pk_bf16_f32 v135, v48, v49
    buffer_store_dwordx4 v[132:135], v5, s[48:51], s36 offen offset:1024 sc1
    v_mfma_f32_32x32x16_bf16 v[176:191], v[28:31], v[50:53], v[176:191]
    s_waitcnt lgkmcnt(3)
    v_mfma_f32_32x32x16_bf16 v[88:103], a[0:3], v[112:115], 0
    ds_read_b128 v[108:111], v5 offset:11264
    s_lshl_b32 s56, s41, 11
    v_add_u32 v2, s56, v5
    ds_read_b128 v[34:37], v2 offset:0
    ds_read_b128 v[38:41], v2 offset:1024
    v_mfma_f32_32x32x16_bf16 v[88:103], a[8:11], v[116:119], v[88:103]
    ds_read_b128 v[112:115], v5 offset:13312
    s_waitcnt lgkmcnt(5)
    v_mfma_f32_32x32x16_bf16 v[88:103], a[16:19], v[120:123], v[88:103]
    ds_read_b128 v[116:119], v5 offset:15360
    v_mul_f32 v42, v176, v176
    v_mul_f32 v43, v177, v177
    v_mul_f32 v44, v178, v178
    v_mul_f32 v45, v179, v179
    v_mul_f32 v46, v180, v180
    v_mul_f32 v47, v181, v181
    v_mfma_f32_32x32x16_bf16 v[88:103], a[24:27], v[124:127], v[88:103]
    ds_read_b128 v[120:123], v5 offset:17408
    v_mul_f32 v48, v182, v182
    v_mul_f32 v49, v183, v183
    v_fma_f32 v42, v42, v59, v58
    v_fma_f32 v43, v43, v59, v58
    v_fma_f32 v44, v44, v59, v58
    v_fma_f32 v45, v45, v59, v58
    s_waitcnt lgkmcnt(5)
    v_mfma_f32_32x32x16_bf16 v[88:103], a[32:35], v[104:107], v[88:103]
    ds_read_b128 v[124:127], v5 offset:19456
    v_fma_f32 v46, v46, v59, v58
    v_fma_f32 v47, v47, v59, v58
    v_fma_f32 v48, v48, v59, v58
    v_fma_f32 v49, v49, v59, v58
    v_mul_f32 v42, v42, v176
    v_mul_f32 v43, v43, v177
    v_mfma_f32_32x32x16_bf16 v[88:103], a[40:43], v[108:111], v[88:103]
    ds_read_b128 v[104:107], v5 offset:21504
    v_mul_f32 v44, v44, v178
    v_mul_f32 v45, v45, v179
    v_mul_f32 v46, v46, v180
    v_mul_f32 v47, v47, v181
    v_mul_f32 v48, v48, v182
    v_mul_f32 v49, v49, v183
    s_waitcnt lgkmcnt(3)
    v_mfma_f32_32x32x16_bf16 v[88:103], a[48:51], v[112:115], v[88:103]
    ds_read_b128 v[108:111], v5 offset:23552
    v_exp_f32 v42, v42
    v_exp_f32 v43, v43
    v_exp_f32 v44, v44
    v_mfma_f32_32x32x16_bf16 v[88:103], a[56:59], v[116:119], v[88:103]
    ds_read_b128 v[112:115], v5 offset:25600
    v_exp_f32 v45, v45
    v_exp_f32 v46, v46
    v_exp_f32 v47, v47
    s_waitcnt lgkmcnt(3)
    v_mfma_f32_32x32x16_bf16 v[88:103], a[64:67], v[120:123], v[88:103]
    buffer_load_dwordx4 v[204:207], v5, s[48:51], s80 offen offset:3072 sc1
    ds_read_b128 v[116:119], v5 offset:27648
    v_exp_f32 v48, v48
    v_exp_f32 v49, v49
    v_fma_f32 v42, v42, v60, v60
    v_fma_f32 v43, v43, v60, v60
    v_mfma_f32_32x32x16_bf16 v[88:103], a[72:75], v[124:127], v[88:103]
    ds_read_b128 v[120:123], v5 offset:29696
    v_fma_f32 v44, v44, v60, v60
    v_fma_f32 v45, v45, v60, v60
    v_fma_f32 v46, v46, v60, v60
    v_fma_f32 v47, v47, v60, v60
    v_fma_f32 v48, v48, v60, v60
    v_fma_f32 v49, v49, v60, v60
    s_waitcnt lgkmcnt(3)
    v_mfma_f32_32x32x16_bf16 v[88:103], a[80:83], v[104:107], v[88:103]
    s_add_u32 s80, s80, 4096
    buffer_load_dwordx4 v[208:211], v5, s[48:51], s80 offen offset:0 sc1
    ds_read_b128 v[124:127], v5 offset:31744
    v_rcp_f32 v42, v42
    v_rcp_f32 v43, v43
    v_rcp_f32 v44, v44
    v_mfma_f32_32x32x16_bf16 v[88:103], a[88:91], v[108:111], v[88:103]
    buffer_load_dwordx4 v[212:215], v5, s[48:51], s80 offen offset:1024 sc1
    ds_read_b128 v[104:107], v5 offset:33792
    v_rcp_f32 v45, v45
    v_rcp_f32 v46, v46
    v_rcp_f32 v47, v47
    s_waitcnt lgkmcnt(3)
    v_mfma_f32_32x32x16_bf16 v[88:103], a[96:99], v[112:115], v[88:103]
    ds_read_b128 v[108:111], v5 offset:35840
    v_rcp_f32 v48, v48
    v_rcp_f32 v49, v49
    v_mul_f32 v42, v42, v176
    v_mul_f32 v43, v43, v177
    v_mfma_f32_32x32x16_bf16 v[88:103], a[104:107], v[116:119], v[88:103]
    buffer_load_dwordx4 v[216:219], v5, s[48:51], s80 offen offset:2048 sc1
    ds_read_b128 v[112:115], v5 offset:37888
    v_mul_f32 v44, v44, v178
    v_mul_f32 v45, v45, v179
    v_mul_f32 v46, v46, v180
    v_mul_f32 v47, v47, v181
    v_mul_f32 v48, v48, v182
    v_mul_f32 v49, v49, v183
    s_waitcnt lgkmcnt(3)
    v_mfma_f32_32x32x16_bf16 v[88:103], a[112:115], v[120:123], v[88:103]
    buffer_load_dwordx4 v[220:223], v5, s[48:51], s80 offen offset:3072 sc1
    ds_read_b128 v[116:119], v5 offset:39936
    v_cvt_pk_bf16_f32 v136, v42, v43
    v_cvt_pk_bf16_f32 v137, v44, v45
    v_cvt_pk_bf16_f32 v138, v46, v47
    v_cvt_pk_bf16_f32 v139, v48, v49
    buffer_store_dwordx4 v[136:139], v5, s[48:51], s36 offen offset:2048 sc1
    v_mfma_f32_32x32x16_bf16 v[88:103], a[120:123], v[124:127], v[88:103]
    ds_read_b128 v[120:123], v5 offset:41984
    v_mul_f32 v42, v184, v184
    v_mul_f32 v43, v185, v185
    v_mul_f32 v44, v186, v186
    v_mul_f32 v45, v187, v187
    v_mul_f32 v46, v188, v188
    v_mul_f32 v47, v189, v189
    s_waitcnt lgkmcnt(3)
    v_mfma_f32_32x32x16_bf16 v[88:103], a[128:131], v[104:107], v[88:103]
    ds_read_b128 v[124:127], v5 offset:44032
    v_mul_f32 v48, v190, v190
    v_mul_f32 v49, v191, v191
    v_fma_f32 v42, v42, v59, v58
    v_fma_f32 v43, v43, v59, v58
    v_fma_f32 v44, v44, v59, v58
    v_fma_f32 v45, v45, v59, v58
    v_mfma_f32_32x32x16_bf16 v[88:103], a[136:139], v[108:111], v[88:103]
    ds_read_b128 v[104:107], v5 offset:46080
    v_fma_f32 v46, v46, v59, v58
    v_fma_f32 v47, v47, v59, v58
    v_fma_f32 v48, v48, v59, v58
    v_fma_f32 v49, v49, v59, v58
    v_mul_f32 v42, v42, v184
    v_mul_f32 v43, v43, v185
    s_waitcnt lgkmcnt(3)
    v_mfma_f32_32x32x16_bf16 v[88:103], a[144:147], v[112:115], v[88:103]
    s_add_u32 s80, s80, 4096
    buffer_load_dwordx4 v[224:227], v5, s[48:51], s80 offen offset:0 sc1
    ds_read_b128 v[108:111], v5 offset:48128
    v_mul_f32 v44, v44, v186
    v_mul_f32 v45, v45, v187
    v_mul_f32 v46, v46, v188
    v_mul_f32 v47, v47, v189
    v_mul_f32 v48, v48, v190
    v_mul_f32 v49, v49, v191
    v_mfma_f32_32x32x16_bf16 v[88:103], a[152:155], v[116:119], v[88:103]
    buffer_load_dwordx4 v[228:231], v5, s[48:51], s80 offen offset:1024 sc1
    ds_read_b128 v[112:115], v5 offset:50176
    v_exp_f32 v42, v42
    v_exp_f32 v43, v43
    v_exp_f32 v44, v44
    s_waitcnt lgkmcnt(3)
    v_mfma_f32_32x32x16_bf16 v[88:103], a[160:163], v[120:123], v[88:103]
    ds_read_b128 v[116:119], v5 offset:52224
    v_exp_f32 v45, v45
    v_exp_f32 v46, v46
    v_exp_f32 v47, v47
    v_mfma_f32_32x32x16_bf16 v[88:103], a[168:171], v[124:127], v[88:103]
    ds_read_b128 v[120:123], v5 offset:54272
    v_exp_f32 v48, v48
    v_exp_f32 v49, v49
    v_fma_f32 v42, v42, v60, v60
    v_fma_f32 v43, v43, v60, v60
    s_waitcnt lgkmcnt(3)
    v_mfma_f32_32x32x16_bf16 v[88:103], a[176:179], v[104:107], v[88:103]
    ds_read_b128 v[124:127], v5 offset:56320
    v_fma_f32 v44, v44, v60, v60
    v_fma_f32 v45, v45, v60, v60
    v_fma_f32 v46, v46, v60, v60
    v_fma_f32 v47, v47, v60, v60
    v_fma_f32 v48, v48, v60, v60
    v_fma_f32 v49, v49, v60, v60
    v_mfma_f32_32x32x16_bf16 v[88:103], a[184:187], v[108:111], v[88:103]
    ds_read_b128 v[104:107], v5 offset:1024
    v_rcp_f32 v42, v42
    v_rcp_f32 v43, v43
    v_rcp_f32 v44, v44
    s_waitcnt lgkmcnt(3)
    v_mfma_f32_32x32x16_bf16 v[88:103], a[192:195], v[112:115], v[88:103]
    ds_read_b128 v[108:111], v5 offset:3072
    v_rcp_f32 v45, v45
    v_rcp_f32 v46, v46
    v_rcp_f32 v47, v47
    v_mfma_f32_32x32x16_bf16 v[88:103], a[200:203], v[116:119], v[88:103]
    ds_read_b128 v[112:115], v5 offset:5120
    v_rcp_f32 v48, v48
    v_rcp_f32 v49, v49
    v_mul_f32 v42, v42, v184
    v_mul_f32 v43, v43, v185
    s_waitcnt lgkmcnt(3)
    v_mfma_f32_32x32x16_bf16 v[88:103], a[208:211], v[120:123], v[88:103]
    ds_read_b128 v[116:119], v5 offset:7168
    v_mul_f32 v44, v44, v186
    v_mul_f32 v45, v45, v187
    v_mul_f32 v46, v46, v188
    v_mul_f32 v47, v47, v189
    v_mul_f32 v48, v48, v190
    v_mul_f32 v49, v49, v191
    v_mfma_f32_32x32x16_bf16 v[88:103], a[216:219], v[124:127], v[88:103]
    buffer_load_dwordx4 v[232:235], v5, s[48:51], s80 offen offset:2048 sc1
    ds_read_b128 v[120:123], v5 offset:9216
    v_cvt_pk_bf16_f32 v140, v42, v43
    v_cvt_pk_bf16_f32 v141, v44, v45
    v_cvt_pk_bf16_f32 v142, v46, v47
    v_cvt_pk_bf16_f32 v143, v48, v49
    buffer_store_dwordx4 v[140:143], v5, s[48:51], s36 offen offset:3072 sc1
    v_mfma_f32_32x32x16_bf16 v[88:103], v[26:29], v[54:57], v[88:103]
    s_add_u32 s36, s36, 114688
    s_waitcnt lgkmcnt(3)
    v_mfma_f32_32x32x16_bf16 v[176:191], a[4:7], v[104:107], 0
    ds_read_b128 v[124:127], v5 offset:11264
    v_mfma_f32_32x32x16_bf16 v[176:191], a[12:15], v[108:111], v[176:191]
    ds_read_b128 v[104:107], v5 offset:13312
    s_waitcnt lgkmcnt(3)
    v_mfma_f32_32x32x16_bf16 v[176:191], a[20:23], v[112:115], v[176:191]
    buffer_load_dwordx4 v[236:239], v5, s[48:51], s80 offen offset:3072 sc1
    ds_read_b128 v[108:111], v5 offset:15360
    s_nop 1
    v_mul_f32 v42, v88, v88
    v_mul_f32 v43, v89, v89
    v_mul_f32 v44, v90, v90
    v_mul_f32 v45, v91, v91
    v_mul_f32 v46, v92, v92
    v_mul_f32 v47, v93, v93
    v_mfma_f32_32x32x16_bf16 v[176:191], a[28:31], v[116:119], v[176:191]
    s_add_u32 s80, s80, 4096
    buffer_load_dwordx4 v[240:243], v5, s[48:51], s80 offen offset:0 sc1
    ds_read_b128 v[112:115], v5 offset:17408
    v_mul_f32 v48, v94, v94
    v_mul_f32 v49, v95, v95
    v_fma_f32 v42, v42, v63, v62
    v_fma_f32 v43, v43, v63, v62
    v_fma_f32 v44, v44, v63, v62
    v_fma_f32 v45, v45, v63, v62
    s_waitcnt lgkmcnt(3)
    v_mfma_f32_32x32x16_bf16 v[176:191], a[36:39], v[120:123], v[176:191]
    ds_read_b128 v[116:119], v5 offset:19456
    v_fma_f32 v46, v46, v63, v62
    v_fma_f32 v47, v47, v63, v62
    v_fma_f32 v48, v48, v63, v62
    v_fma_f32 v49, v49, v63, v62
    v_mul_f32 v42, v42, v88
    v_mul_f32 v43, v43, v89
    v_mfma_f32_32x32x16_bf16 v[176:191], a[44:47], v[124:127], v[176:191]
    buffer_load_dwordx4 v[244:247], v5, s[48:51], s80 offen offset:1024 sc1
    ds_read_b128 v[120:123], v5 offset:21504
    v_mul_f32 v44, v44, v90
    v_mul_f32 v45, v45, v91
    v_mul_f32 v46, v46, v92
    v_mul_f32 v47, v47, v93
    v_mul_f32 v48, v48, v94
    v_mul_f32 v49, v49, v95
    s_waitcnt lgkmcnt(3)
    v_mfma_f32_32x32x16_bf16 v[176:191], a[52:55], v[104:107], v[176:191]
    buffer_load_dwordx4 v[248:251], v5, s[48:51], s80 offen offset:2048 sc1
    ds_read_b128 v[124:127], v5 offset:23552
    v_exp_f32 v42, v42
    v_exp_f32 v43, v43
    v_exp_f32 v44, v44
    v_mfma_f32_32x32x16_bf16 v[176:191], a[60:63], v[108:111], v[176:191]
    ds_read_b128 v[104:107], v5 offset:25600
    v_exp_f32 v45, v45
    v_exp_f32 v46, v46
    v_exp_f32 v47, v47
    s_waitcnt lgkmcnt(3)
    v_mfma_f32_32x32x16_bf16 v[176:191], a[68:71], v[112:115], v[176:191]
    ds_read_b128 v[108:111], v5 offset:27648
    v_exp_f32 v48, v48
    v_exp_f32 v49, v49
    v_fma_f32 v42, v42, v64, v64
    v_fma_f32 v43, v43, v64, v64
    v_mfma_f32_32x32x16_bf16 v[176:191], a[76:79], v[116:119], v[176:191]
    ds_read_b128 v[112:115], v5 offset:29696
    v_fma_f32 v44, v44, v64, v64
    v_fma_f32 v45, v45, v64, v64
    v_fma_f32 v46, v46, v64, v64
    v_fma_f32 v47, v47, v64, v64
    v_fma_f32 v48, v48, v64, v64
    v_fma_f32 v49, v49, v64, v64
    s_waitcnt lgkmcnt(3)
    v_mfma_f32_32x32x16_bf16 v[176:191], a[84:87], v[120:123], v[176:191]
    buffer_load_dwordx4 v[252:255], v5, s[48:51], s80 offen offset:3072 sc1
    ds_read_b128 v[116:119], v5 offset:31744
    v_rcp_f32 v42, v42
    v_rcp_f32 v43, v43
    v_rcp_f32 v44, v44
    v_mfma_f32_32x32x16_bf16 v[176:191], a[92:95], v[124:127], v[176:191]
    s_add_u32 s80, s80, 4096
    buffer_load_dwordx4 a[0:3], v5, s[48:51], s80 offen offset:0 sc1
    ds_read_b128 v[120:123], v5 offset:33792
    v_rcp_f32 v45, v45
    v_rcp_f32 v46, v46
    v_rcp_f32 v47, v47
    s_waitcnt lgkmcnt(3)
    v_mfma_f32_32x32x16_bf16 v[176:191], a[100:103], v[104:107], v[176:191]
    ds_read_b128 v[124:127], v5 offset:35840
    v_rcp_f32 v48, v48
    v_rcp_f32 v49, v49
    v_mul_f32 v42, v42, v88
    v_mul_f32 v43, v43, v89
    v_mfma_f32_32x32x16_bf16 v[176:191], a[108:111], v[108:111], v[176:191]
    ds_read_b128 v[104:107], v5 offset:37888
    v_mul_f32 v44, v44, v90
    v_mul_f32 v45, v45, v91
    v_mul_f32 v46, v46, v92
    v_mul_f32 v47, v47, v93
    v_mul_f32 v48, v48, v94
    v_mul_f32 v49, v49, v95
    s_waitcnt lgkmcnt(3)
    v_mfma_f32_32x32x16_bf16 v[176:191], a[116:119], v[112:115], v[176:191]
    ds_read_b128 v[108:111], v5 offset:39936
    v_cvt_pk_bf16_f32 v144, v42, v43
    v_cvt_pk_bf16_f32 v145, v44, v45
    v_cvt_pk_bf16_f32 v146, v46, v47
    v_cvt_pk_bf16_f32 v147, v48, v49
    buffer_store_dwordx4 v[144:147], v5, s[48:51], s36 offen offset:0 sc1
    v_mfma_f32_32x32x16_bf16 v[176:191], a[124:127], v[116:119], v[176:191]
    ds_read_b128 v[112:115], v5 offset:41984
    v_mul_f32 v42, v96, v96
    v_mul_f32 v43, v97, v97
    v_mul_f32 v44, v98, v98
    v_mul_f32 v45, v99, v99
    v_mul_f32 v46, v100, v100
    v_mul_f32 v47, v101, v101
    s_waitcnt lgkmcnt(3)
    v_mfma_f32_32x32x16_bf16 v[176:191], a[132:135], v[120:123], v[176:191]
    ds_read_b128 v[116:119], v5 offset:44032
    v_mul_f32 v48, v102, v102
    v_mul_f32 v49, v103, v103
    v_fma_f32 v42, v42, v63, v62
    v_fma_f32 v43, v43, v63, v62
    v_fma_f32 v44, v44, v63, v62
    v_fma_f32 v45, v45, v63, v62
    v_mfma_f32_32x32x16_bf16 v[176:191], a[140:143], v[124:127], v[176:191]
    buffer_load_dwordx4 a[8:11], v5, s[48:51], s80 offen offset:1024 sc1
    ds_read_b128 v[120:123], v5 offset:46080
    v_fma_f32 v46, v46, v63, v62
    v_fma_f32 v47, v47, v63, v62
    v_fma_f32 v48, v48, v63, v62
    v_fma_f32 v49, v49, v63, v62
    v_mul_f32 v42, v42, v96
    v_mul_f32 v43, v43, v97
    s_waitcnt lgkmcnt(3)
    v_mfma_f32_32x32x16_bf16 v[176:191], a[148:151], v[104:107], v[176:191]
    ds_read_b128 v[124:127], v5 offset:48128
    v_mul_f32 v44, v44, v98
    v_mul_f32 v45, v45, v99
    v_mul_f32 v46, v46, v100
    v_mul_f32 v47, v47, v101
    v_mul_f32 v48, v48, v102
    v_mul_f32 v49, v49, v103
    v_mfma_f32_32x32x16_bf16 v[176:191], a[156:159], v[108:111], v[176:191]
    ds_read_b128 v[104:107], v5 offset:50176
    v_exp_f32 v42, v42
    v_exp_f32 v43, v43
    v_exp_f32 v44, v44
    s_waitcnt vmcnt(8)
    s_mov_b64 exec, 1
    s_cmp_eq_u32 s84, 0
    s_cbranch_scc1 Lfa_23
    buffer_store_dword v19, off, s[48:51], s75 offset:256 sc1
    s_branch Lfb_24
Lfa_23:
    buffer_store_dword v19, off, s[48:51], s75 offset:256
Lfb_24:
    s_mov_b64 exec, -1
    s_waitcnt lgkmcnt(3)
    v_mfma_f32_32x32x16_bf16 v[176:191], a[164:167], v[112:115], v[176:191]
    buffer_load_dwordx4 a[16:19], v5, s[48:51], s80 offen offset:2048 sc1
    ds_read_b128 v[108:111], v5 offset:52224
    v_exp_f32 v45, v45
    v_exp_f32 v46, v46
    v_exp_f32 v47, v47
    v_mfma_f32_32x32x16_bf16 v[176:191], a[172:175], v[116:119], v[176:191]
    buffer_load_dwordx4 a[24:27], v5, s[48:51], s80 offen offset:3072 sc1
    ds_read_b128 v[112:115], v5 offset:54272
    v_exp_f32 v48, v48
    v_exp_f32 v49, v49
    v_fma_f32 v42, v42, v64, v64
    v_fma_f32 v43, v43, v64, v64
    s_waitcnt lgkmcnt(3)
    v_mfma_f32_32x32x16_bf16 v[176:191], a[180:183], v[120:123], v[176:191]
    s_add_u32 s80, s80, 4096
    buffer_load_dwordx4 a[32:35], v5, s[48:51], s80 offen offset:0 sc1
    ds_read_b128 v[116:119], v5 offset:56320
    v_fma_f32 v44, v44, v64, v64
    v_fma_f32 v45, v45, v64, v64
    v_fma_f32 v46, v46, v64, v64
    v_fma_f32 v47, v47, v64, v64
    v_fma_f32 v48, v48, v64, v64
    v_fma_f32 v49, v49, v64, v64
    v_mfma_f32_32x32x16_bf16 v[176:191], a[188:191], v[124:127], v[176:191]
    v_rcp_f32 v42, v42
    v_rcp_f32 v43, v43
    v_rcp_f32 v44, v44
    s_waitcnt lgkmcnt(2)
    v_mfma_f32_32x32x16_bf16 v[176:191], a[196:199], v[104:107], v[176:191]
    buffer_load_dwordx4 a[40:43], v5, s[48:51], s80 offen offset:1024 sc1
    v_rcp_f32 v45, v45
    v_rcp_f32 v46, v46
    v_rcp_f32 v47, v47
    v_mfma_f32_32x32x16_bf16 v[176:191], a[204:207], v[108:111], v[176:191]
    v_rcp_f32 v48, v48
    v_rcp_f32 v49, v49
    v_mul_f32 v42, v42, v96
    v_mul_f32 v43, v43, v97
    s_waitcnt lgkmcnt(0)
    v_mfma_f32_32x32x16_bf16 v[176:191], a[212:215], v[112:115], v[176:191]
    buffer_load_dwordx4 a[48:51], v5, s[48:51], s80 offen offset:2048 sc1
    v_mul_f32 v44, v44, v98
    v_mul_f32 v45, v45, v99
    v_mul_f32 v46, v46, v100
    v_mul_f32 v47, v47, v101
    v_mul_f32 v48, v48, v102
    v_mul_f32 v49, v49, v103
    v_mfma_f32_32x32x16_bf16 v[176:191], a[220:223], v[116:119], v[176:191]
    buffer_load_dwordx4 a[56:59], v5, s[48:51], s80 offen offset:3072 sc1
    v_cvt_pk_bf16_f32 v148, v42, v43
    v_cvt_pk_bf16_f32 v149, v44, v45
    v_cvt_pk_bf16_f32 v150, v46, v47
    v_cvt_pk_bf16_f32 v151, v48, v49
    buffer_store_dwordx4 v[148:151], v5, s[48:51], s36 offen offset:1024 sc1
    v_mfma_f32_32x32x16_bf16 v[176:191], v[28:31], v[54:57], v[176:191]
    v_min_u32 v1, 7, v0
    v_lshlrev_b32 v1, 7, v1
    s_add_u32 s68, s77, 262144
    s_add_u32 s68, s68, s39
    buffer_load_dword v22, v1, s[48:51], s68 offen sc1
    s_nop 6
    v_pk_mul_f32 v[160:161], v[176:177], v[176:177]
    v_pk_mul_f32 v[162:163], v[178:179], v[178:179]
    v_pk_mul_f32 v[164:165], v[180:181], v[180:181]
    v_pk_mul_f32 v[166:167], v[182:183], v[182:183]
    s_add_u32 s69, s74, 256
    buffer_load_dword v23, v18, s[48:51], s69 offen sc1
    v_pk_mul_f32 v[168:169], v[184:185], v[184:185]
    v_pk_mul_f32 v[170:171], v[186:187], v[186:187]
    v_pk_mul_f32 v[172:173], v[188:189], v[188:189]
    v_pk_mul_f32 v[174:175], v[190:191], v[190:191]
    v_pk_fma_f32 v[160:161], v[160:161], v[62:63], v[62:63] op_sel:[0,1,0] op_sel_hi:[1,1,0]
    v_pk_fma_f32 v[162:163], v[162:163], v[62:63], v[62:63] op_sel:[0,1,0] op_sel_hi:[1,1,0]
    v_pk_fma_f32 v[164:165], v[164:165], v[62:63], v[62:63] op_sel:[0,1,0] op_sel_hi:[1,1,0]
    v_pk_fma_f32 v[166:167], v[166:167], v[62:63], v[62:63] op_sel:[0,1,0] op_sel_hi:[1,1,0]
    v_pk_fma_f32 v[168:169], v[168:169], v[62:63], v[62:63] op_sel:[0,1,0] op_sel_hi:[1,1,0]
    v_pk_fma_f32 v[170:171], v[170:171], v[62:63], v[62:63] op_sel:[0,1,0] op_sel_hi:[1,1,0]
    v_pk_fma_f32 v[172:173], v[172:173], v[62:63], v[62:63] op_sel:[0,1,0] op_sel_hi:[1,1,0]
    v_pk_fma_f32 v[174:175], v[174:175], v[62:63], v[62:63] op_sel:[0,1,0] op_sel_hi:[1,1,0]
    v_pk_mul_f32 v[160:161], v[160:161], v[176:177]
    v_pk_mul_f32 v[162:163], v[162:163], v[178:179]
    s_add_u32 s80, s80, 4096
    buffer_load_dwordx4 a[64:67], v5, s[48:51], s80 offen offset:0 sc1
    v_pk_mul_f32 v[164:165], v[164:165], v[180:181]
    buffer_load_dwordx4 a[72:75], v5, s[48:51], s80 offen offset:1024 sc1
    v_pk_mul_f32 v[166:167], v[166:167], v[182:183]
    v_pk_mul_f32 v[168:169], v[168:169], v[184:185]
    v_pk_mul_f32 v[170:171], v[170:171], v[186:187]
    v_pk_mul_f32 v[172:173], v[172:173], v[188:189]
    v_pk_mul_f32 v[174:175], v[174:175], v[190:191]
    v_exp_f32 v160, v160
    v_exp_f32 v161, v161
    v_exp_f32 v162, v162
    v_exp_f32 v163, v163
    buffer_load_dwordx4 a[80:83], v5, s[48:51], s80 offen offset:2048 sc1
    buffer_load_dword v24, v18, s[48:51], s69 offen sc1
    v_exp_f32 v164, v164
    v_exp_f32 v165, v165
    v_exp_f32 v166, v166
    v_exp_f32 v167, v167
    v_exp_f32 v168, v168
    v_exp_f32 v169, v169
    buffer_load_dwordx4 a[88:91], v5, s[48:51], s80 offen offset:3072 sc1
    v_exp_f32 v170, v170
    v_exp_f32 v171, v171
    v_exp_f32 v172, v172
    v_exp_f32 v173, v173
    v_exp_f32 v174, v174
    v_exp_f32 v175, v175
    s_add_u32 s80, s80, 4096
    buffer_load_dwordx4 a[96:99], v5, s[48:51], s80 offen offset:0 sc1
    v_pk_fma_f32 v[160:161], v[160:161], v[64:65], v[64:65] op_sel_hi:[1,0,0]
    v_pk_fma_f32 v[162:163], v[162:163], v[64:65], v[64:65] op_sel_hi:[1,0,0]
    v_pk_fma_f32 v[164:165], v[164:165], v[64:65], v[64:65] op_sel_hi:[1,0,0]
    v_pk_fma_f32 v[166:167], v[166:167], v[64:65], v[64:65] op_sel_hi:[1,0,0]
    v_pk_fma_f32 v[168:169], v[168:169], v[64:65], v[64:65] op_sel_hi:[1,0,0]
    v_pk_fma_f32 v[170:171], v[170:171], v[64:65], v[64:65] op_sel_hi:[1,0,0]
    v_pk_fma_f32 v[172:173], v[172:173], v[64:65], v[64:65] op_sel_hi:[1,0,0]
    v_pk_fma_f32 v[174:175], v[174:175], v[64:65], v[64:65] op_sel_hi:[1,0,0]
    v_rcp_f32 v160, v160
    v_rcp_f32 v161, v161
    buffer_load_dwordx4 a[104:107], v5, s[48:51], s80 offen offset:1024 sc1
    v_rcp_f32 v162, v162
    v_rcp_f32 v163, v163
    buffer_load_dword v25, v18, s[48:51], s69 offen sc1
    v_rcp_f32 v164, v164
    v_rcp_f32 v165, v165
    v_rcp_f32 v166, v166
    v_rcp_f32 v167, v167
    buffer_load_dwordx4 a[112:115], v5, s[48:51], s80 offen offset:2048 sc1
    v_rcp_f32 v168, v168
    v_rcp_f32 v169, v169
    v_rcp_f32 v170, v170
    v_rcp_f32 v171, v171
    v_rcp_f32 v172, v172
    v_rcp_f32 v173, v173
    v_rcp_f32 v174, v174
    v_rcp_f32 v175, v175
    v_pk_mul_f32 v[160:161], v[160:161], v[176:177]
    v_pk_mul_f32 v[162:163], v[162:163], v[178:179]
    v_pk_mul_f32 v[164:165], v[164:165], v[180:181]
    v_pk_mul_f32 v[166:167], v[166:167], v[182:183]
    v_pk_mul_f32 v[168:169], v[168:169], v[184:185]
    v_pk_mul_f32 v[170:171], v[170:171], v[186:187]
    v_pk_mul_f32 v[172:173], v[172:173], v[188:189]
    v_pk_mul_f32 v[174:175], v[174:175], v[190:191]
    v_cvt_pk_bf16_f32 v152, v160, v161
    v_cvt_pk_bf16_f32 v153, v162, v163
    v_cvt_pk_bf16_f32 v154, v164, v165
    v_cvt_pk_bf16_f32 v155, v166, v167
    buffer_load_dword v26, v18, s[48:51], s69 offen sc1
    v_cvt_pk_bf16_f32 v156, v168, v169
    buffer_load_dwordx4 a[120:123], v5, s[48:51], s80 offen offset:3072 sc1
    v_cvt_pk_bf16_f32 v157, v170, v171
    v_cvt_pk_bf16_f32 v158, v172, v173
    v_cvt_pk_bf16_f32 v159, v174, v175
    buffer_store_dwordx4 v[152:155], v5, s[48:51], s36 offen offset:2048 sc1
    buffer_store_dwordx4 v[156:159], v5, s[48:51], s36 offen offset:3072 sc1
    v_add_u32 v2, s65, v5
    s_mov_b32 s60, -1
    s_waitcnt vmcnt(14)
    v_cmp_ne_u32 vcc, s55, v22
    s_nop 0
    s_and_b32 s61, vcc_lo, s60
    s_cbranch_scc0 Lskip_25
    s_mov_b32 s59, 0
    s_nop 1
Lloop_26:
    s_sleep 4
    buffer_load_dword v22, v1, s[48:51], s68 offen sc1
    s_add_u32 s59, s59, 1
    s_waitcnt vmcnt(0)
    v_cmp_ne_u32 vcc, s55, v22
    s_nop 0
    s_and_b32 s61, vcc_lo, s60
    s_cselect_b32 s61, s59, 0x40000
    s_cmp_lt_u32 s61, 0x40000
    s_cbranch_scc1 Lloop_26
Lskip_25:
    s_lshl_b32 s56, s41, 16
    s_lshl_b32 s57, s54, 8
    s_add_u32 s56, s56, s57
    s_add_u32 s56, s56, 6160384
    s_add_u32 s57, s56, 0
    buffer_load_dword v42, v21, s[48:51], s57 offen offset:0 sc1
    buffer_load_dword v46, v21, s[48:51], s57 offen offset:128 sc1
    s_add_u32 s57, s56, 8192
    buffer_load_dword v43, v21, s[48:51], s57 offen offset:0 sc1
    buffer_load_dword v47, v21, s[48:51], s57 offen offset:128 sc1
    s_add_u32 s57, s56, 32768
    buffer_load_dword v44, v21, s[48:51], s57 offen offset:0 sc1
    buffer_load_dword v48, v21, s[48:51], s57 offen offset:128 sc1
    s_add_u32 s57, s56, 40960
    buffer_load_dword v45, v21, s[48:51], s57 offen offset:0 sc1
    buffer_load_dword v49, v21, s[48:51], s57 offen offset:128 sc1
    v_mfma_f32_32x32x16_bf16 v[160:175], a[224:227], v[128:131], 0
    s_add_u32 s80, s80, 4096
    buffer_load_dwordx4 a[128:131], v5, s[48:51], s80 offen offset:0 sc1
    v_mfma_f32_32x32x16_bf16 v[176:191], a[228:231], v[128:131], 0
    buffer_load_dwordx4 a[136:139], v5, s[48:51], s80 offen offset:1024 sc1
    ds_read_b128 a[160:163], v2 offset:0
    buffer_load_dwordx4 a[144:147], v5, s[48:51], s80 offen offset:2048 sc1
    buffer_load_dwordx4 a[152:155], v5, s[48:51], s80 offen offset:3072 sc1
    s_lshl_b32 s60, 0x1111111, s52
    s_waitcnt vmcnt(25)
    v_cmp_ne_u32 vcc, s55, v23
    s_nop 0
    s_and_b32 s61, vcc_lo, s60
    s_cbranch_scc0 Lskip_27
    s_waitcnt vmcnt(21)
    v_cmp_ne_u32 vcc, s55, v24
    s_nop 0
    s_and_b32 s61, vcc_lo, s60
    s_cbranch_scc0 Lskip_28
    s_waitcnt vmcnt(17)
    v_cmp_ne_u32 vcc, s55, v25
    s_nop 0
    s_and_b32 s61, vcc_lo, s60
    s_cbranch_scc0 Lskip_29
    s_waitcnt vmcnt(15)
    v_cmp_ne_u32 vcc, s55, v26
    s_nop 0
    s_and_b32 s61, vcc_lo, s60
    s_cbranch_scc0 Lskip_30
    s_mov_b32 s59, 0
    s_nop 1
Lloop_31:
    buffer_load_dword v23, v18, s[48:51], s69 offen sc1
    s_add_u32 s59, s59, 1
    s_waitcnt vmcnt(0)
    v_cmp_ne_u32 vcc, s55, v23
    s_nop 0
    s_and_b32 s61, vcc_lo, s60
    s_cselect_b32 s61, s59, 0x40000
    s_cmp_lt_u32 s61, 0x40000
    s_cbranch_scc1 Lloop_31
Lskip_30:
Lskip_29:
Lskip_28:
Lskip_27:
    v_mfma_f32_32x32x16_bf16 v[160:175], a[232:235], v[132:135], v[160:175]
    ds_read_b128 a[168:171], v2 offset:1024
    v_mfma_f32_32x32x16_bf16 v[176:191], a[236:239], v[132:135], v[176:191]
    s_add_u32 s62, s53, 1
    s_sub_u32 s63, s62, 7
    s_cselect_b32 s62, s62, s63
    s_lshl_b32 s62, s62, 14
    s_add_u32 s27, s62, s79
    buffer_load_dwordx4 a[36:39], v5, s[48:51], s27 offen offset:0 sc1
    ds_read_b128 a[176:179], v2 offset:2048
    v_mfma_f32_32x32x16_bf16 v[160:175], a[240:243], v[136:139], v[160:175]
    ds_read_b128 a[184:187], v2 offset:3072
    s_xor_b32 s56, s52, 1
    s_mul_i32 s56, s56, 6144
    s_add_u32 s56, s56, 0
    v_add_u32 v28, s56, v5
    v_mfma_f32_32x32x16_bf16 v[176:191], a[244:247], v[136:139], v[176:191]
    s_add_u32 s62, s53, 2
    s_sub_u32 s63, s62, 7
    s_cselect_b32 s62, s62, s63
    s_lshl_b32 s62, s62, 14
    s_add_u32 s42, s62, s79
    buffer_load_dwordx4 a[44:47], v5, s[48:51], s42 offen offset:0 sc1
    ds_read_b128 a[192:195], v2 offset:4096
    v_mfma_f32_32x32x16_bf16 v[160:175], a[248:251], v[140:143], v[160:175]
    ds_read_b128 a[200:203], v2 offset:5120
    v_mfma_f32_32x32x16_bf16 v[176:191], a[252:255], v[140:143], v[176:191]
    s_xor_b32 s56, s52, 2
    s_mul_i32 s56, s56, 6144
    s_add_u32 s56, s56, 2048
    v_add_u32 v29, s56, v5
    v_mfma_f32_32x32x16_bf16 v[96:111], a[224:227], v[144:147], 0
    ds_read_b128 a[208:211], v2 offset:6144
    v_mfma_f32_32x32x16_bf16 v[112:127], a[228:231], v[144:147], 0
    ds_read_b128 a[216:219], v2 offset:7168
    s_xor_b32 s56, s52, 3
    s_mul_i32 s56, s56, 6144
    s_add_u32 s56, s56, 4096
    v_add_u32 v30, s56, v5
    v_mfma_f32_32x32x16_bf16 v[96:111], a[232:235], v[148:151], v[96:111]
    s_add_u32 s62, s53, 3
    s_sub_u32 s63, s62, 7
    s_cselect_b32 s62, s62, s63
    s_lshl_b32 s62, s62, 14
    s_add_u32 s43, s62, s79
    buffer_load_dwordx4 a[52:55], v5, s[48:51], s43 offen offset:0 sc1
    ds_read_b128 a[4:7], v2 offset:8192
    v_mfma_f32_32x32x16_bf16 v[112:127], a[236:239], v[148:151], v[112:127]
    ds_read_b128 a[12:15], v2 offset:9216
    v_mfma_f32_32x32x16_bf16 v[96:111], a[240:243], v[152:155], v[96:111]
    ds_read_b128 a[20:23], v2 offset:10240
    s_mul_i32 s56, s52, 6144
    v_add_u32 v27, s56, v5
    v_mfma_f32_32x32x16_bf16 v[112:127], a[244:247], v[152:155], v[112:127]
    ds_read_b128 a[28:31], v2 offset:11264
    v_mfma_f32_32x32x16_bf16 v[96:111], a[248:251], v[156:159], v[96:111]
    s_lshl_b32 s56, s52, 5
    s_add_u32 s36, s3, s56
    v_mfma_f32_32x32x16_bf16 v[112:127], a[252:255], v[156:159], v[112:127]
    s_add_u32 s62, s53, 4
    s_sub_u32 s63, s62, 7
    s_cselect_b32 s62, s62, s63
    s_lshl_b32 s62, s62, 14
    s_add_u32 s64, s62, s79
    buffer_load_dwordx4 a[60:63], v5, s[48:51], s64 offen offset:0 sc1
    s_barrier
    s_add_u32 s62, s53, 5
    s_sub_u32 s63, s62, 7
    s_cselect_b32 s62, s62, s63
    s_lshl_b32 s62, s62, 14
    s_add_u32 s66, s62, s79
    buffer_load_dwordx4 a[68:71], v5, s[48:51], s66 offen offset:0 sc1
    s_add_u32 s62, s53, 6
    s_sub_u32 s63, s62, 7
    s_cselect_b32 s62, s62, s63
    s_lshl_b32 s62, s62, 14
    s_add_u32 s67, s62, s79
    buffer_load_dwordx4 a[76:79], v5, s[48:51], s67 offen offset:0 sc1
    s_waitcnt vmcnt(18)
    s_mov_b64 exec, 1
    s_cmp_eq_u32 s84, 0
    s_cbranch_scc1 Lfa_32
    buffer_store_dword v19, off, s[48:51], s75 offset:384 sc1
    s_branch Lfb_33
Lfa_32:
    buffer_store_dword v19, off, s[48:51], s75 offset:384
Lfb_33:
    s_mov_b64 exec, -1
    buffer_load_dwordx4 a[84:87], v5, s[48:51], s27 offen offset:1024 sc1
    buffer_load_dwordx4 a[92:95], v5, s[48:51], s42 offen offset:1024 sc1
    buffer_load_dwordx4 a[100:103], v5, s[48:51], s43 offen offset:1024 sc1
    buffer_load_dwordx4 a[108:111], v5, s[48:51], s64 offen offset:1024 sc1
    buffer_load_dwordx4 a[116:119], v5, s[48:51], s66 offen offset:1024 sc1
    s_waitcnt vmcnt(11) lgkmcnt(11)
    v_mfma_f32_32x32x16_bf16 v[160:175], a[160:163], a[36:39], v[160:175]
    s_waitcnt lgkmcnt(10)
    v_mfma_f32_32x32x16_bf16 v[176:191], a[168:171], a[36:39], v[176:191]
    buffer_load_dwordx4 a[124:127], v5, s[48:51], s67 offen offset:1024 sc1
    s_waitcnt vmcnt(11) lgkmcnt(9)
    v_mfma_f32_32x32x16_bf16 v[160:175], a[176:179], a[44:47], v[160:175]
    s_waitcnt lgkmcnt(8)
    v_mfma_f32_32x32x16_bf16 v[176:191], a[184:187], a[44:47], v[176:191]
    s_add_u32 s68, s74, 384
    buffer_load_dword v1, v18, s[48:51], s68 offen sc1
    buffer_load_dwordx4 a[132:135], v5, s[48:51], s27 offen offset:2048 sc1
    s_waitcnt vmcnt(12) lgkmcnt(7)
    v_mfma_f32_32x32x16_bf16 v[160:175], a[192:195], a[52:55], v[160:175]
    s_waitcnt lgkmcnt(6)
    v_mfma_f32_32x32x16_bf16 v[176:191], a[200:203], a[52:55], v[176:191]
    buffer_load_dwordx4 a[140:143], v5, s[48:51], s42 offen offset:2048 sc1
    s_waitcnt vmcnt(12) lgkmcnt(5)
    v_mfma_f32_32x32x16_bf16 v[160:175], a[208:211], a[60:63], v[160:175]
    s_waitcnt lgkmcnt(4)
    v_mfma_f32_32x32x16_bf16 v[176:191], a[216:219], a[60:63], v[176:191]
    buffer_load_dwordx4 a[148:151], v5, s[48:51], s43 offen offset:2048 sc1
    s_waitcnt vmcnt(12) lgkmcnt(3)
    v_mfma_f32_32x32x16_bf16 v[160:175], a[4:7], a[68:71], v[160:175]
    v_lshlrev_b32 v50, 16, v6
    v_and_b32 v51, 0xffff0000, v6
    s_waitcnt lgkmcnt(2)
    v_mfma_f32_32x32x16_bf16 v[176:191], a[12:15], a[68:71], v[176:191]
    v_lshlrev_b32 v58, 16, v34
    v_and_b32 v59, 0xffff0000, v34
    v_lshlrev_b32 v52, 16, v7
    buffer_load_dwordx4 a[156:159], v5, s[48:51], s64 offen offset:2048 sc1
    s_waitcnt vmcnt(12) lgkmcnt(1)
    v_mfma_f32_32x32x16_bf16 v[160:175], a[20:23], a[76:79], v[160:175]
    v_and_b32 v53, 0xffff0000, v7
    v_lshlrev_b32 v60, 16, v35
    s_waitcnt lgkmcnt(0)
    v_mfma_f32_32x32x16_bf16 v[176:191], a[28:31], a[76:79], v[176:191]
    v_and_b32 v61, 0xffff0000, v35
    v_lshlrev_b32 v54, 16, v8
    v_and_b32 v55, 0xffff0000, v8
    buffer_load_dword v22, v18, s[48:51], s68 offen sc1
    buffer_load_dwordx4 a[164:167], v5, s[48:51], s66 offen offset:2048 sc1
    s_waitcnt vmcnt(12)
    v_mfma_f32_32x32x16_bf16 v[160:175], v[192:195], a[84:87], v[160:175]
    v_lshlrev_b32 v62, 16, v36
    v_and_b32 v63, 0xffff0000, v36
    v_lshlrev_b32 v56, 16, v9
    v_mfma_f32_32x32x16_bf16 v[176:191], v[196:199], a[84:87], v[176:191]
    v_and_b32 v57, 0xffff0000, v9
    v_lshlrev_b32 v64, 16, v37
    buffer_load_dwordx4 a[172:175], v5, s[48:51], s67 offen offset:2048 sc1
    s_waitcnt vmcnt(12)
    v_mfma_f32_32x32x16_bf16 v[160:175], v[200:203], a[92:95], v[160:175]
    v_and_b32 v65, 0xffff0000, v37
    v_mul_f32 v14, v14, v15
    v_add_f32 v80, v50, v58
    v_mfma_f32_32x32x16_bf16 v[176:191], v[204:207], a[92:95], v[176:191]
    v_add_f32 v81, v51, v59
    v_add_f32 v82, v52, v60
    v_add_f32 v83, v53, v61
    buffer_load_dwordx4 a[180:183], v5, s[48:51], s27 offen offset:3072 sc1
    s_waitcnt vmcnt(12)
    v_mfma_f32_32x32x16_bf16 v[160:175], v[208:211], a[100:103], v[160:175]
    v_add_f32 v84, v54, v62
    v_add_f32 v85, v55, v63
    v_mfma_f32_32x32x16_bf16 v[176:191], v[212:215], a[100:103], v[176:191]
    v_add_f32 v86, v56, v64
    v_add_f32 v87, v57, v65
    v_fma_f32 v50, v50, v15, -v14
    buffer_load_dwordx4 a[188:191], v5, s[48:51], s42 offen offset:3072 sc1
    s_waitcnt vmcnt(12)
    v_mfma_f32_32x32x16_bf16 v[160:175], v[216:219], a[108:111], v[160:175]
    v_fma_f32 v51, v51, v15, -v14
    v_fma_f32 v52, v52, v15, -v14
    v_fma_f32 v53, v53, v15, -v14
    v_mfma_f32_32x32x16_bf16 v[176:191], v[220:223], a[108:111], v[176:191]
    buffer_load_dword v23, v18, s[48:51], s68 offen sc1
    v_fma_f32 v54, v54, v15, -v14
    v_fma_f32 v55, v55, v15, -v14
    buffer_load_dwordx4 a[196:199], v5, s[48:51], s43 offen offset:3072 sc1
    s_waitcnt vmcnt(13)
    v_mfma_f32_32x32x16_bf16 v[160:175], v[224:227], a[116:119], v[160:175]
    v_fma_f32 v56, v56, v15, -v14
    v_fma_f32 v57, v57, v15, -v14
    v_lshlrev_b32 v58, 16, v42
    v_mfma_f32_32x32x16_bf16 v[176:191], v[228:231], a[116:119], v[176:191]
    v_and_b32 v59, 0xffff0000, v42
    v_lshlrev_b32 v60, 16, v43
    v_and_b32 v61, 0xffff0000, v43
    buffer_load_dwordx4 a[204:207], v5, s[48:51], s64 offen offset:3072 sc1
    s_waitcnt vmcnt(13)
    v_mfma_f32_32x32x16_bf16 v[160:175], v[232:235], a[124:127], v[160:175]
    v_lshlrev_b32 v62, 16, v44
    v_and_b32 v63, 0xffff0000, v44
    v_mfma_f32_32x32x16_bf16 v[176:191], v[236:239], a[124:127], v[176:191]
    v_lshlrev_b32 v64, 16, v45
    v_and_b32 v65, 0xffff0000, v45
    v_fmac_f32 v80, v50, v58
    buffer_load_dwordx4 a[212:215], v5, s[48:51], s66 offen offset:3072 sc1
    s_waitcnt vmcnt(12)
    v_mfma_f32_32x32x16_bf16 v[160:175], v[240:243], a[132:135], v[160:175]
    v_fmac_f32 v81, v51, v59
    v_fmac_f32 v82, v52, v60
    v_fmac_f32 v83, v53, v61
    v_mfma_f32_32x32x16_bf16 v[176:191], v[244:247], a[132:135], v[176:191]
    v_fmac_f32 v84, v54, v62
    v_fmac_f32 v85, v55, v63
    buffer_load_dwordx4 a[220:223], v5, s[48:51], s67 offen offset:3072 sc1
    s_waitcnt vmcnt(12)
    v_mfma_f32_32x32x16_bf16 v[160:175], v[248:251], a[140:143], v[160:175]
    v_fmac_f32 v86, v56, v64
    v_fmac_f32 v87, v57, v65
    v_lshlrev_b32 v50, 16, v10
    v_mfma_f32_32x32x16_bf16 v[176:191], v[252:255], a[140:143], v[176:191]
    v_and_b32 v51, 0xffff0000, v10
    v_lshlrev_b32 v58, 16, v38
    s_lshl_b32 s60, 0x1111111, s52
    v_cmp_ne_u32 vcc, s55, v1
    s_nop 0
    s_and_b32 s61, vcc_lo, s60
    s_cbranch_scc0 Lskip_34
    s_waitcnt vmcnt(9)
    v_cmp_ne_u32 vcc, s55, v22
    s_nop 0
    s_and_b32 s61, vcc_lo, s60
    s_cbranch_scc0 Lskip_35
    s_waitcnt vmcnt(4)
    v_cmp_ne_u32 vcc, s55, v23
    s_nop 0
    s_and_b32 s61, vcc_lo, s60
    s_cbranch_scc0 Lskip_36
    s_mov_b32 s59, 0
    s_nop 1
Lloop_37:
    buffer_load_dword v1, v18, s[48:51], s68 offen sc1
    s_add_u32 s59, s59, 1
    s_waitcnt vmcnt(0)
    v_cmp_ne_u32 vcc, s55, v1
    s_nop 0
    s_and_b32 s61, vcc_lo, s60
    s_cselect_b32 s61, s59, 0x40000
    s_cmp_lt_u32 s61, 0x40000
    s_cbranch_scc1 Lloop_37
Lskip_36:
Lskip_35:
Lskip_34:
    s_add_u32 s27, s27, 114688
    buffer_load_dwordx4 a[224:227], v5, s[48:51], s27 offen offset:0 sc1
    s_waitcnt vmcnt(12)
    v_mfma_f32_32x32x16_bf16 v[160:175], a[0:3], a[148:151], v[160:175]
    v_and_b32 v59, 0xffff0000, v38
    v_lshlrev_b32 v52, 16, v11
    v_and_b32 v53, 0xffff0000, v11
    v_mfma_f32_32x32x16_bf16 v[176:191], a[8:11], a[148:151], v[176:191]
    v_lshlrev_b32 v60, 16, v39
    v_and_b32 v61, 0xffff0000, v39
    v_lshlrev_b32 v54, 16, v12
    s_add_u32 s42, s42, 114688
    buffer_load_dwordx4 a[228:231], v5, s[48:51], s42 offen offset:0 sc1
    s_waitcnt vmcnt(12)
    v_mfma_f32_32x32x16_bf16 v[160:175], a[16:19], a[156:159], v[160:175]
    v_and_b32 v55, 0xffff0000, v12
    v_lshlrev_b32 v62, 16, v40
    v_mfma_f32_32x32x16_bf16 v[176:191], a[24:27], a[156:159], v[176:191]
    v_and_b32 v63, 0xffff0000, v40
    v_lshlrev_b32 v56, 16, v13
    v_and_b32 v57, 0xffff0000, v13
    s_add_u32 s43, s43, 114688
    buffer_load_dwordx4 a[232:235], v5, s[48:51], s43 offen offset:0 sc1
    s_waitcnt vmcnt(11)
    v_mfma_f32_32x32x16_bf16 v[160:175], a[32:35], a[164:167], v[160:175]
    v_lshlrev_b32 v64, 16, v41
    v_and_b32 v65, 0xffff0000, v41
    v_mul_f32 v16, v16, v17
    v_mfma_f32_32x32x16_bf16 v[176:191], a[40:43], a[164:167], v[176:191]
    v_add_f32 v88, v50, v58
    v_add_f32 v89, v51, v59
    s_add_u32 s64, s64, 114688
    buffer_load_dwordx4 a[236:239], v5, s[48:51], s64 offen offset:0 sc1
    s_waitcnt vmcnt(11)
    v_mfma_f32_32x32x16_bf16 v[160:175], a[48:51], a[172:175], v[160:175]
    v_add_f32 v90, v52, v60
    v_add_f32 v91, v53, v61
    v_add_f32 v92, v54, v62
    v_mfma_f32_32x32x16_bf16 v[176:191], a[56:59], a[172:175], v[176:191]
    v_add_f32 v93, v55, v63
    v_add_f32 v94, v56, v64
    v_add_f32 v95, v57, v65
    s_add_u32 s66, s66, 114688
    buffer_load_dwordx4 a[240:243], v5, s[48:51], s66 offen offset:0 sc1
    s_waitcnt vmcnt(11)
    v_mfma_f32_32x32x16_bf16 v[160:175], a[64:67], a[180:183], v[160:175]
    v_fma_f32 v50, v50, v17, -v16
    v_fma_f32 v51, v51, v17, -v16
    v_mfma_f32_32x32x16_bf16 v[176:191], a[72:75], a[180:183], v[176:191]
    v_fma_f32 v52, v52, v17, -v16
    v_fma_f32 v53, v53, v17, -v16
    v_fma_f32 v54, v54, v17, -v16
    s_add_u32 s67, s67, 114688
    buffer_load_dwordx4 a[244:247], v5, s[48:51], s67 offen offset:0 sc1
    s_waitcnt vmcnt(11)
    v_mfma_f32_32x32x16_bf16 v[160:175], a[80:83], a[188:191], v[160:175]
    v_fma_f32 v55, v55, v17, -v16
    v_fma_f32 v56, v56, v17, -v16
    v_fma_f32 v57, v57, v17, -v16
    v_mfma_f32_32x32x16_bf16 v[176:191], a[88:91], a[188:191], v[176:191]
    v_lshlrev_b32 v58, 16, v46
    v_and_b32 v59, 0xffff0000, v46
    buffer_load_dwordx4 a[248:251], v5, s[48:51], s27 offen offset:1024 sc1
    s_waitcnt vmcnt(10)
    v_mfma_f32_32x32x16_bf16 v[160:175], a[96:99], a[196:199], v[160:175]
    v_lshlrev_b32 v60, 16, v47
    v_and_b32 v61, 0xffff0000, v47
    v_lshlrev_b32 v62, 16, v48
    v_mfma_f32_32x32x16_bf16 v[176:191], a[104:107], a[196:199], v[176:191]
    v_and_b32 v63, 0xffff0000, v48
    v_lshlrev_b32 v64, 16, v49
    v_and_b32 v65, 0xffff0000, v49
    buffer_load_dwordx4 a[252:255], v5, s[48:51], s42 offen offset:1024 sc1
    s_waitcnt vmcnt(10)
    v_mfma_f32_32x32x16_bf16 v[160:175], a[112:115], a[204:207], v[160:175]
    v_fmac_f32 v88, v50, v58
    v_fmac_f32 v89, v51, v59
    v_mfma_f32_32x32x16_bf16 v[176:191], a[120:123], a[204:207], v[176:191]
    v_fmac_f32 v90, v52, v60
    v_fmac_f32 v91, v53, v61
    v_fmac_f32 v92, v54, v62
    buffer_load_dwordx4 v[128:131], v5, s[48:51], s43 offen offset:1024 sc1
    s_waitcnt vmcnt(10)
    v_mfma_f32_32x32x16_bf16 v[160:175], a[128:131], a[212:215], v[160:175]
    v_fmac_f32 v93, v55, v63
    v_fmac_f32 v94, v56, v64
    v_fmac_f32 v95, v57, v65
    v_mfma_f32_32x32x16_bf16 v[176:191], a[136:139], a[212:215], v[176:191]
    buffer_load_dwordx4 v[132:135], v5, s[48:51], s64 offen offset:1024 sc1
    s_waitcnt vmcnt(10)
    v_mfma_f32_32x32x16_bf16 v[160:175], a[144:147], a[220:223], v[160:175]
    v_mfma_f32_32x32x16_bf16 v[176:191], a[152:155], a[220:223], v[176:191]
    buffer_load_dwordx4 v[136:139], v5, s[48:51], s66 offen offset:1024 sc1
    s_waitcnt vmcnt(10)
    v_mfma_f32_32x32x16_bf16 v[96:111], a[160:163], a[224:227], v[96:111]
    v_mfma_f32_32x32x16_bf16 v[112:127], a[168:171], a[224:227], v[112:127]
    buffer_load_dwordx4 v[140:143], v5, s[48:51], s67 offen offset:1024 sc1
    s_waitcnt vmcnt(10)
    v_mfma_f32_32x32x16_bf16 v[96:111], a[176:179], a[228:231], v[96:111]
    s_nop 3
    ds_write_b128 v28, v[168:171] offset:0
    v_mfma_f32_32x32x16_bf16 v[112:127], a[184:187], a[228:231], v[112:127]
    buffer_load_dwordx4 v[144:147], v5, s[48:51], s27 offen offset:2048 sc1
    s_waitcnt vmcnt(10)
    v_mfma_f32_32x32x16_bf16 v[96:111], a[192:195], a[232:235], v[96:111]
    ds_write_b128 v28, v[172:175] offset:1024
    v_mfma_f32_32x32x16_bf16 v[112:127], a[200:203], a[232:235], v[112:127]
    ds_write_b128 v29, v[176:179] offset:0
    buffer_load_dwordx4 v[148:151], v5, s[48:51], s42 offen offset:2048 sc1
    s_waitcnt vmcnt(10)
    v_mfma_f32_32x32x16_bf16 v[96:111], a[208:211], a[236:239], v[96:111]
    v_mfma_f32_32x32x16_bf16 v[112:127], a[216:219], a[236:239], v[112:127]
    ds_write_b128 v29, v[180:183] offset:1024
    buffer_load_dwordx4 v[152:155], v5, s[48:51], s43 offen offset:2048 sc1
    s_waitcnt vmcnt(10)
    v_mfma_f32_32x32x16_bf16 v[96:111], a[4:7], a[240:243], v[96:111]
    v_mfma_f32_32x32x16_bf16 v[112:127], a[12:15], a[240:243], v[112:127]
    ds_write_b128 v30, v[184:187] offset:0
    buffer_load_dwordx4 v[156:159], v5, s[48:51], s64 offen offset:2048 sc1
    s_waitcnt vmcnt(10)
    v_mfma_f32_32x32x16_bf16 v[96:111], a[20:23], a[244:247], v[96:111]
    ds_write_b128 v30, v[188:191] offset:1024
    v_mfma_f32_32x32x16_bf16 v[112:127], a[28:31], a[244:247], v[112:127]
    buffer_load_dwordx4 a[36:39], v5, s[48:51], s66 offen offset:2048 sc1
    s_waitcnt vmcnt(10)
    v_mfma_f32_32x32x16_bf16 v[96:111], v[192:195], a[248:251], v[96:111]
    v_mfma_f32_32x32x16_bf16 v[112:127], v[196:199], a[248:251], v[112:127]
    v_add_f32 v160, v160, v80
    v_add_f32 v161, v161, v81
    buffer_load_dwordx4 a[44:47], v5, s[48:51], s67 offen offset:2048 sc1
    s_waitcnt vmcnt(10)
    v_mfma_f32_32x32x16_bf16 v[96:111], v[200:203], a[252:255], v[96:111]
    v_add_f32 v162, v162, v82
    v_add_f32 v163, v163, v83
    v_add_f32 v164, v164, v84
    v_mfma_f32_32x32x16_bf16 v[112:127], v[204:207], a[252:255], v[112:127]
    v_add_f32 v165, v165, v85
    v_add_f32 v166, v166, v86
    buffer_load_dwordx4 a[52:55], v5, s[48:51], s27 offen offset:3072 sc1
    s_waitcnt vmcnt(10)
    v_mfma_f32_32x32x16_bf16 v[96:111], v[208:211], v[128:131], v[96:111]
    v_add_f32 v167, v167, v87
    s_waitcnt lgkmcnt(0)
    s_barrier
    ds_read_b128 v[168:171], v27 offset:0
    v_mfma_f32_32x32x16_bf16 v[112:127], v[212:215], v[128:131], v[112:127]
    ds_read_b128 v[172:175], v27 offset:1024
    ds_read_b128 v[176:179], v27 offset:2048
    buffer_load_dwordx4 a[60:63], v5, s[48:51], s42 offen offset:3072 sc1
    s_waitcnt vmcnt(10)
    v_mfma_f32_32x32x16_bf16 v[96:111], v[216:219], v[132:135], v[96:111]
    ds_read_b128 v[180:183], v27 offset:3072
    ds_read_b128 v[184:187], v27 offset:4096
    ds_read_b128 v[188:191], v27 offset:5120
    v_mfma_f32_32x32x16_bf16 v[112:127], v[220:223], v[132:135], v[112:127]
    s_waitcnt lgkmcnt(5)
    v_add_f32 v160, v160, v168
    v_add_f32 v161, v161, v169
    buffer_load_dwordx4 a[68:71], v5, s[48:51], s43 offen offset:3072 sc1
    s_waitcnt vmcnt(10)
    v_mfma_f32_32x32x16_bf16 v[96:111], v[224:227], v[136:139], v[96:111]
    v_add_f32 v162, v162, v170
    v_add_f32 v163, v163, v171
    s_waitcnt lgkmcnt(4)
    v_add_f32 v164, v164, v172
    v_mfma_f32_32x32x16_bf16 v[112:127], v[228:231], v[136:139], v[112:127]
    v_add_f32 v165, v165, v173
    v_add_f32 v166, v166, v174
    v_add_f32 v167, v167, v175
    buffer_load_dwordx4 a[76:79], v5, s[48:51], s64 offen offset:3072 sc1
    s_waitcnt vmcnt(10)
    v_mfma_f32_32x32x16_bf16 v[96:111], v[232:235], v[140:143], v[96:111]
    s_waitcnt lgkmcnt(3)
    v_add_f32 v160, v160, v176
    v_add_f32 v161, v161, v177
    v_mfma_f32_32x32x16_bf16 v[112:127], v[236:239], v[140:143], v[112:127]
    v_add_f32 v162, v162, v178
    v_add_f32 v163, v163, v179
    s_waitcnt lgkmcnt(2)
    v_add_f32 v164, v164, v180
    buffer_load_dwordx4 a[84:87], v5, s[48:51], s66 offen offset:3072 sc1
    s_waitcnt vmcnt(10)
    v_mfma_f32_32x32x16_bf16 v[96:111], v[240:243], v[144:147], v[96:111]
    v_add_f32 v165, v165, v181
    v_add_f32 v166, v166, v182
    v_mfma_f32_32x32x16_bf16 v[112:127], v[244:247], v[144:147], v[112:127]
    v_add_f32 v167, v167, v183
    s_waitcnt lgkmcnt(1)
    v_add_f32 v160, v160, v184
    v_add_f32 v161, v161, v185
    buffer_load_dwordx4 a[92:95], v5, s[48:51], s67 offen offset:3072 sc1
    s_waitcnt vmcnt(10)
    v_mfma_f32_32x32x16_bf16 v[96:111], v[248:251], v[148:151], v[96:111]
    v_add_f32 v162, v162, v186
    v_add_f32 v163, v163, v187
    v_mfma_f32_32x32x16_bf16 v[112:127], v[252:255], v[148:151], v[112:127]
    s_waitcnt lgkmcnt(0)
    v_add_f32 v164, v164, v188
    v_add_f32 v165, v165, v189
    v_add_f32 v166, v166, v190
    s_waitcnt vmcnt(9)
    v_mfma_f32_32x32x16_bf16 v[96:111], a[0:3], v[152:155], v[96:111]
    v_add_f32 v167, v167, v191
    v_cvt_pk_bf16_f32 v168, v160, v161
    v_mfma_f32_32x32x16_bf16 v[112:127], a[8:11], v[152:155], v[112:127]
    v_cvt_pk_bf16_f32 v169, v162, v163
    v_cvt_pk_bf16_f32 v170, v164, v165
    v_cvt_pk_bf16_f32 v171, v166, v167
    s_waitcnt vmcnt(8)
    v_mfma_f32_32x32x16_bf16 v[96:111], a[16:19], v[156:159], v[96:111]
    v_permlane32_swap_b32 v168, v170
    v_permlane32_swap_b32 v169, v171
    buffer_store_dwordx4 v[168:171], v20, s[44:47], s36 offen
    v_mfma_f32_32x32x16_bf16 v[112:127], a[24:27], v[156:159], v[112:127]
    s_waitcnt vmcnt(8)
    v_mfma_f32_32x32x16_bf16 v[96:111], a[32:35], a[36:39], v[96:111]
    v_mfma_f32_32x32x16_bf16 v[112:127], a[40:43], a[36:39], v[112:127]
    s_waitcnt vmcnt(7)
    v_mfma_f32_32x32x16_bf16 v[96:111], a[48:51], a[44:47], v[96:111]
    v_mfma_f32_32x32x16_bf16 v[112:127], a[56:59], a[44:47], v[112:127]
    s_waitcnt vmcnt(6)
    v_mfma_f32_32x32x16_bf16 v[96:111], a[64:67], a[52:55], v[96:111]
    v_mfma_f32_32x32x16_bf16 v[112:127], a[72:75], a[52:55], v[112:127]
    s_waitcnt vmcnt(5)
    v_mfma_f32_32x32x16_bf16 v[96:111], a[80:83], a[60:63], v[96:111]
    v_mfma_f32_32x32x16_bf16 v[112:127], a[88:91], a[60:63], v[112:127]
    s_waitcnt vmcnt(4)
    v_mfma_f32_32x32x16_bf16 v[96:111], a[96:99], a[68:71], v[96:111]
    v_mfma_f32_32x32x16_bf16 v[112:127], a[104:107], a[68:71], v[112:127]
    s_waitcnt vmcnt(3)
    v_mfma_f32_32x32x16_bf16 v[96:111], a[112:115], a[76:79], v[96:111]
    v_mfma_f32_32x32x16_bf16 v[112:127], a[120:123], a[76:79], v[112:127]
    s_waitcnt vmcnt(2)
    v_mfma_f32_32x32x16_bf16 v[96:111], a[128:131], a[84:87], v[96:111]
    v_mfma_f32_32x32x16_bf16 v[112:127], a[136:139], a[84:87], v[112:127]
    s_waitcnt vmcnt(1)
    v_mfma_f32_32x32x16_bf16 v[96:111], a[144:147], a[92:95], v[96:111]
    v_mfma_f32_32x32x16_bf16 v[112:127], a[152:155], a[92:95], v[112:127]
    s_nop 10
    ds_write_b128 v28, v[104:107] offset:24576
    ds_write_b128 v28, v[108:111] offset:25600
    ds_write_b128 v29, v[112:115] offset:24576
    ds_write_b128 v29, v[116:119] offset:25600
    ds_write_b128 v30, v[120:123] offset:24576
    ds_write_b128 v30, v[124:127] offset:25600
    v_pk_add_f32 v[96:97], v[96:97], v[88:89]
    v_pk_add_f32 v[98:99], v[98:99], v[90:91]
    v_pk_add_f32 v[100:101], v[100:101], v[92:93]
    v_pk_add_f32 v[102:103], v[102:103], v[94:95]
    s_waitcnt lgkmcnt(0)
    s_barrier
    ds_read_b128 v[104:107], v27 offset:24576
    ds_read_b128 v[108:111], v27 offset:25600
    ds_read_b128 v[112:115], v27 offset:26624
    ds_read_b128 v[116:119], v27 offset:27648
    ds_read_b128 v[120:123], v27 offset:28672
    ds_read_b128 v[124:127], v27 offset:29696
    s_waitcnt lgkmcnt(5)
    v_pk_add_f32 v[96:97], v[96:97], v[104:105]
    v_pk_add_f32 v[98:99], v[98:99], v[106:107]
    s_waitcnt lgkmcnt(4)
    v_pk_add_f32 v[100:101], v[100:101], v[108:109]
    v_pk_add_f32 v[102:103], v[102:103], v[110:111]
    s_waitcnt lgkmcnt(3)
    v_pk_add_f32 v[96:97], v[96:97], v[112:113]
    v_pk_add_f32 v[98:99], v[98:99], v[114:115]
    s_waitcnt lgkmcnt(2)
    v_pk_add_f32 v[100:101], v[100:101], v[116:117]
    v_pk_add_f32 v[102:103], v[102:103], v[118:119]
    s_waitcnt lgkmcnt(1)
    v_pk_add_f32 v[96:97], v[96:97], v[120:121]
    v_pk_add_f32 v[98:99], v[98:99], v[122:123]
    s_waitcnt lgkmcnt(0)
    v_pk_add_f32 v[100:101], v[100:101], v[124:125]
    v_pk_add_f32 v[102:103], v[102:103], v[126:127]
    v_cvt_pk_bf16_f32 v104, v96, v97
    v_cvt_pk_bf16_f32 v105, v98, v99
    v_cvt_pk_bf16_f32 v106, v100, v101
    v_cvt_pk_bf16_f32 v107, v102, v103
    s_nop 0
    v_permlane32_swap_b32 v104, v106
    v_permlane32_swap_b32 v105, v107
    s_add_u32 s36, s36, 28672
    buffer_store_dwordx4 v[104:107], v20, s[44:47], s36 offen
    s_or_b32 s56, s54, s41
    s_mov_b32 s57, 126976
    s_cselect_b32 s56, 0x7ffff000, s57
    buffer_store_dword v19, v18, s[48:51], s56 offen sc1
    s_endpgm
L_spare:
    s_load_dwordx2 s[36:37], s[0:1], 72
    s_load_dwordx2 s[40:41], s[0:1], 80
    s_sub_u32 s60, s2, 224
    s_mov_b32 s34, 401408
    s_mov_b32 s35, 0x20000
    s_mov_b32 s38, 1605632
    s_mov_b32 s39, 0x20000
    s_mov_b32 s42, 1605632
    s_mov_b32 s43, 0x20000
    s_mov_b32 s50, 18837504
    s_mov_b32 s51, 0x20000
    v_lshlrev_b32 v5, 7, v0
    v_and_b32 v0, 63, v0
    v_mov_b32 v7, 126976
    s_cmp_ge_u32 s60, 28
    s_cbranch_scc1 L_tag
    s_lshr_b32 s61, s60, 2
    s_and_b32 s62, s60, 3
    v_lshrrev_b32 v11, 3, v0
    v_and_b32 v12, 7, v0
    v_and_b32 v13, 2, v11
    v_lshlrev_b32 v13, 1, v13
    v_xor_b32 v13, v13, v12
    v_lshlrev_b32 v13, 4, v13
    v_mul_u32_u24 v14, 896, v11
    v_add_u32 v15, v13, v14
    v_lshl_add_u32 v16, v14, 2, v13
    s_mul_i32 s63, s52, 14336
    s_mul_i32 s64, s52, 57344
    s_lshl_b32 s65, s60, 7
    s_add_u32 s64, s64, s65
    s_add_u32 m0, s63, 0
    s_waitcnt lgkmcnt(0)
    buffer_load_dwordx4 v16, s[36:39], s64 offen  lds
    s_add_u32 m0, s63, 1024
    s_add_u32 s64, s64, 28672
    buffer_load_dwordx4 v16, s[36:39], s64 offen  lds
    s_add_u32 m0, s63, 2048
    s_add_u32 s64, s64, 200704
    buffer_load_dwordx4 v16, s[36:39], s64 offen  lds
    s_add_u32 m0, s63, 3072
    s_add_u32 s64, s64, 28672
    buffer_load_dwordx4 v16, s[36:39], s64 offen  lds
    s_add_u32 m0, s63, 4096
    s_add_u32 s64, s64, 200704
    buffer_load_dwordx4 v16, s[36:39], s64 offen  lds
    s_add_u32 m0, s63, 5120
    s_add_u32 s64, s64, 28672
    buffer_load_dwordx4 v16, s[36:39], s64 offen  lds
    s_add_u32 m0, s63, 6144
    s_add_u32 s64, s64, 200704
    buffer_load_dwordx4 v16, s[36:39], s64 offen  lds
    s_add_u32 m0, s63, 7168
    s_add_u32 s64, s64, 28672
    buffer_load_dwordx4 v16, s[36:39], s64 offen  lds
    s_add_u32 m0, s63, 8192
    s_add_u32 s64, s64, 200704
    buffer_load_dwordx4 v16, s[36:39], s64 offen  lds
    s_add_u32 m0, s63, 9216
    s_add_u32 s64, s64, 28672
    buffer_load_dwordx4 v16, s[36:39], s64 offen  lds
    s_add_u32 m0, s63, 10240
    s_add_u32 s64, s64, 200704
    buffer_load_dwordx4 v16, s[36:39], s64 offen  lds
    s_add_u32 m0, s63, 11264
    s_add_u32 s64, s64, 28672
    buffer_load_dwordx4 v16, s[36:39], s64 offen  lds
    s_add_u32 m0, s63, 12288
    s_add_u32 s64, s64, 200704
    buffer_load_dwordx4 v16, s[36:39], s64 offen  lds
    s_add_u32 m0, s63, 13312
    s_add_u32 s64, s64, 28672
    buffer_load_dwordx4 v16, s[36:39], s64 offen  lds
    buffer_load_dword v7, v7, s[48:51], 0 offen sc1
    s_mul_i32 s74, s62, 57344
    s_lshl_b32 s65, s61, 7
    s_add_u32 s74, s74, s65
    s_mul_i32 s65, s52, 14336
    s_add_u32 s74, s74, s65
    v_and_b32 v17, 15, v0
    v_lshrrev_b32 v18, 4, v0
    v_lshrrev_b32 v19, 5, v0
    v_and_b32 v20, 3, v0
    v_lshlrev_b32 v20, 3, v20
    v_lshrrev_b32 v21, 2, v17
    v_lshl_add_u32 v20, v21, 7, v20
    v_lshrrev_b32 v21, 3, v17
    v_and_b32 v22, 1, v18
    v_lshl_add_u32 v21, v21, 1, v22
    v_lshl_add_u32 v20, v21, 5, v20
    v_lshl_add_u32 v20, v19, 9, v20
    v_add_u32 v20, s63, v20
    v_xor_b32 v21, 64, v20
    s_lshl_b32 s65, s62, 5
    v_xor_b32 v22, s65, v20
    v_add_u32 v22, 57344, v22
    v_xor_b32 v23, 64, v22
    v_lshlrev_b32 v24, 4, v0
    v_mov_b32 v28, 0x3f803f80
    v_mov_b32 v29, 0x3f803f80
    v_mov_b32 v30, 0x3f803f80
    v_mov_b32 v31, 0x3f803f80
    s_mul_i32 s66, s60, 115712
    s_add_u32 s66, s66, 15335424
    s_lshl_b32 s73, s60, 11
    s_lshl_b32 s65, s52, 7
    s_add_u32 s73, s73, s65
    s_add_u32 s73, s73, 65536
    v_and_b32 v27, 31, v0
    v_lshlrev_b32 v27, 2, v27
    s_lshl_b32 s75, s52, 10
    s_add_u32 s64, s66, s75
    s_lshl_b32 s75, s75, 1
    s_waitcnt vmcnt(13)
    ds_read_b64_tr_b16 v[64:65], v20 offset:0
    ds_read_b64_tr_b16 v[68:69], v21 offset:0
    ds_read_b64_tr_b16 v[66:67], v20 offset:1024
    ds_read_b64_tr_b16 v[70:71], v21 offset:1024
    s_waitcnt vmcnt(11)
    ds_read_b64_tr_b16 v[72:73], v20 offset:2048
    ds_read_b64_tr_b16 v[76:77], v21 offset:2048
    ds_read_b64_tr_b16 v[74:75], v20 offset:3072
    ds_read_b64_tr_b16 v[78:79], v21 offset:3072
    s_waitcnt lgkmcnt(5)
    buffer_store_dwordx4 v[64:67], v24, s[48:51], s64 offen sc1
    s_waitcnt vmcnt(10)
    ds_read_b64_tr_b16 v[80:81], v20 offset:4096
    ds_read_b64_tr_b16 v[84:85], v21 offset:4096
    ds_read_b64_tr_b16 v[82:83], v20 offset:5120
    ds_read_b64_tr_b16 v[86:87], v21 offset:5120
    s_add_u32 s64, s64, 4096
    s_waitcnt lgkmcnt(5)
    buffer_store_dwordx4 v[72:75], v24, s[48:51], s64 offen sc1
    s_waitcnt vmcnt(9)
    ds_read_b64_tr_b16 v[88:89], v20 offset:6144
    ds_read_b64_tr_b16 v[92:93], v21 offset:6144
    ds_read_b64_tr_b16 v[90:91], v20 offset:7168
    ds_read_b64_tr_b16 v[94:95], v21 offset:7168
    s_add_u32 s64, s64, 4096
    s_waitcnt lgkmcnt(5)
    buffer_store_dwordx4 v[80:83], v24, s[48:51], s64 offen sc1
    s_waitcnt vmcnt(8)
    ds_read_b64_tr_b16 v[96:97], v20 offset:8192
    ds_read_b64_tr_b16 v[100:101], v21 offset:8192
    ds_read_b64_tr_b16 v[98:99], v20 offset:9216
    ds_read_b64_tr_b16 v[102:103], v21 offset:9216
    s_add_u32 s64, s64, 4096
    s_waitcnt lgkmcnt(5)
    buffer_store_dwordx4 v[88:91], v24, s[48:51], s64 offen sc1
    s_waitcnt vmcnt(7)
    ds_read_b64_tr_b16 v[104:105], v20 offset:10240
    ds_read_b64_tr_b16 v[108:109], v21 offset:10240
    ds_read_b64_tr_b16 v[106:107], v20 offset:11264
    ds_read_b64_tr_b16 v[110:111], v21 offset:11264
    s_add_u32 s64, s64, 4096
    s_waitcnt lgkmcnt(5)
    buffer_store_dwordx4 v[96:99], v24, s[48:51], s64 offen sc1
    s_waitcnt vmcnt(6)
    ds_read_b64_tr_b16 v[112:113], v20 offset:12288
    ds_read_b64_tr_b16 v[116:117], v21 offset:12288
    ds_read_b64_tr_b16 v[114:115], v20 offset:13312
    ds_read_b64_tr_b16 v[118:119], v21 offset:13312
    s_add_u32 s64, s64, 4096
    s_waitcnt lgkmcnt(5)
    buffer_store_dwordx4 v[104:107], v24, s[48:51], s64 offen sc1
    s_add_u32 s64, s64, 4096
    s_waitcnt lgkmcnt(1)
    buffer_store_dwordx4 v[112:115], v24, s[48:51], s64 offen sc1
    s_waitcnt vmcnt(7)
    v_readfirstlane_b32 s55, v7
    s_nop 0
    s_mul_i32 s55, s55, 0x9e3779b1
    s_add_u32 s55, s55, 0x7f4a7c15
    v_mov_b32 v2, s55
    s_waitcnt vmcnt(0)
    buffer_store_dword v2, v27, s[48:51], s73 offen offset:0 sc1
    s_add_u32 s64, s64, 4096
    buffer_store_dwordx4 v[68:71], v24, s[48:51], s64 offen sc1
    s_add_u32 s64, s64, 4096
    buffer_store_dwordx4 v[76:79], v24, s[48:51], s64 offen sc1
    s_add_u32 s64, s64, 4096
    buffer_store_dwordx4 v[84:87], v24, s[48:51], s64 offen sc1
    s_add_u32 s64, s64, 4096
    buffer_store_dwordx4 v[92:95], v24, s[48:51], s64 offen sc1
    s_add_u32 s64, s64, 4096
    buffer_store_dwordx4 v[100:103], v24, s[48:51], s64 offen sc1
    s_add_u32 s64, s64, 4096
    buffer_store_dwordx4 v[108:111], v24, s[48:51], s64 offen sc1
    s_add_u32 s64, s64, 4096
    s_waitcnt lgkmcnt(0)
    buffer_store_dwordx4 v[116:119], v24, s[48:51], s64 offen sc1
    s_add_u32 s71, s61, 0
    s_sub_u32 s72, s71, 7
    s_cselect_b32 s71, s71, s72
    s_mul_i32 s71, s71, 229376
    s_add_u32 m0, s63, 57344
    s_add_u32 s71, s71, s74
    buffer_load_dwordx4 v15, s[40:43], s71 offen  lds
    s_add_u32 s71, s61, 0
    s_sub_u32 s72, s71, 7
    s_cselect_b32 s71, s71, s72
    s_mul_i32 s71, s71, 229376
    s_add_u32 m0, s63, 58368
    s_add_u32 s71, s71, s74
    s_add_u32 s71, s71, 7168
    buffer_load_dwordx4 v15, s[40:43], s71 offen  lds
    s_add_u32 s71, s61, 1
    s_sub_u32 s72, s71, 7
    s_cselect_b32 s71, s71, s72
    s_mul_i32 s71, s71, 229376
    s_add_u32 m0, s63, 59392
    s_add_u32 s71, s71, s74
    buffer_load_dwordx4 v15, s[40:43], s71 offen  lds
    s_add_u32 s71, s61, 1
    s_sub_u32 s72, s71, 7
    s_cselect_b32 s71, s71, s72
    s_mul_i32 s71, s71, 229376
    s_add_u32 m0, s63, 60416
    s_add_u32 s71, s71, s74
    s_add_u32 s71, s71, 7168
    buffer_load_dwordx4 v15, s[40:43], s71 offen  lds
    s_add_u32 s71, s61, 2
    s_sub_u32 s72, s71, 7
    s_cselect_b32 s71, s71, s72
    s_mul_i32 s71, s71, 229376
    s_add_u32 m0, s63, 61440
    s_add_u32 s71, s71, s74
    buffer_load_dwordx4 v15, s[40:43], s71 offen  lds
    s_add_u32 s71, s61, 2
    s_sub_u32 s72, s71, 7
    s_cselect_b32 s71, s71, s72
    s_mul_i32 s71, s71, 229376
    s_add_u32 m0, s63, 62464
    s_add_u32 s71, s71, s74
    s_add_u32 s71, s71, 7168
    buffer_load_dwordx4 v15, s[40:43], s71 offen  lds
    s_add_u32 s71, s61, 3
    s_sub_u32 s72, s71, 7
    s_cselect_b32 s71, s71, s72
    s_mul_i32 s71, s71, 229376
    s_add_u32 m0, s63, 63488
    s_add_u32 s71, s71, s74
    buffer_load_dwordx4 v15, s[40:43], s71 offen  lds
    v_mfma_f32_32x32x16_bf16 v[32:47], v[28:31], v[64:67], 0
    v_mfma_f32_32x32x16_bf16 v[48:63], v[28:31], v[68:71], 0
    v_mfma_f32_32x32x16_bf16 v[32:47], v[28:31], v[72:75], v[32:47]
    v_mfma_f32_32x32x16_bf16 v[48:63], v[28:31], v[76:79], v[48:63]
    v_mfma_f32_32x32x16_bf16 v[32:47], v[28:31], v[80:83], v[32:47]
    v_mfma_f32_32x32x16_bf16 v[48:63], v[28:31], v[84:87], v[48:63]
    v_mfma_f32_32x32x16_bf16 v[32:47], v[28:31], v[88:91], v[32:47]
    v_mfma_f32_32x32x16_bf16 v[48:63], v[28:31], v[92:95], v[48:63]
    v_mfma_f32_32x32x16_bf16 v[32:47], v[28:31], v[96:99], v[32:47]
    v_mfma_f32_32x32x16_bf16 v[48:63], v[28:31], v[100:103], v[48:63]
    v_mfma_f32_32x32x16_bf16 v[32:47], v[28:31], v[104:107], v[32:47]
    v_mfma_f32_32x32x16_bf16 v[48:63], v[28:31], v[108:111], v[48:63]
    v_mfma_f32_32x32x16_bf16 v[32:47], v[28:31], v[112:115], v[32:47]
    v_mfma_f32_32x32x16_bf16 v[48:63], v[28:31], v[116:119], v[48:63]
    s_waitcnt vmcnt(7)
    buffer_store_dword v2, v27, s[48:51], s73 offen offset:512 sc1
    s_add_u32 s71, s61, 3
    s_sub_u32 s72, s71, 7
    s_cselect_b32 s71, s71, s72
    s_mul_i32 s71, s71, 229376
    s_add_u32 m0, s63, 64512
    s_add_u32 s71, s71, s74
    s_add_u32 s71, s71, 7168
    buffer_load_dwordx4 v15, s[40:43], s71 offen  lds
    s_add_u32 s71, s61, 4
    s_sub_u32 s72, s71, 7
    s_cselect_b32 s71, s71, s72
    s_mul_i32 s71, s71, 229376
    s_add_u32 m0, s63, 65536
    s_add_u32 s71, s71, s74
    buffer_load_dwordx4 v15, s[40:43], s71 offen  lds
    s_add_u32 s71, s61, 4
    s_sub_u32 s72, s71, 7
    s_cselect_b32 s71, s71, s72
    s_mul_i32 s71, s71, 229376
    s_add_u32 m0, s63, 66560
    s_add_u32 s71, s71, s74
    s_add_u32 s71, s71, 7168
    buffer_load_dwordx4 v15, s[40:43], s71 offen  lds
    s_add_u32 s71, s61, 5
    s_sub_u32 s72, s71, 7
    s_cselect_b32 s71, s71, s72
    s_mul_i32 s71, s71, 229376
    s_add_u32 m0, s63, 67584
    s_add_u32 s71, s71, s74
    buffer_load_dwordx4 v15, s[40:43], s71 offen  lds
    s_add_u32 s71, s61, 5
    s_sub_u32 s72, s71, 7
    s_cselect_b32 s71, s71, s72
    s_mul_i32 s71, s71, 229376
    s_add_u32 m0, s63, 68608
    s_add_u32 s71, s71, s74
    s_add_u32 s71, s71, 7168
    buffer_load_dwordx4 v15, s[40:43], s71 offen  lds
    s_add_u32 s71, s61, 6
    s_sub_u32 s72, s71, 7
    s_cselect_b32 s71, s71, s72
    s_mul_i32 s71, s71, 229376
    s_add_u32 m0, s63, 69632
    s_add_u32 s71, s71, s74
    buffer_load_dwordx4 v15, s[40:43], s71 offen  lds
    s_add_u32 s71, s61, 6
    s_sub_u32 s72, s71, 7
    s_cselect_b32 s71, s71, s72
    s_mul_i32 s71, s71, 229376
    s_add_u32 m0, s63, 70656
    s_add_u32 s71, s71, s74
    s_add_u32 s71, s71, 7168
    buffer_load_dwordx4 v15, s[40:43], s71 offen  lds
    s_lshl_b32 s65, s52, 9
    v_lshlrev_b32 v25, 3, v0
    v_add_u32 v25, 114688, v25
    v_add_u32 v26, s65, v25
    v_mov_b32 v33, v48
    ds_write_b64 v26, v[32:33]
    s_add_u32 s64, s66, s75
    s_add_u32 s64, s64, 57344
    s_waitcnt vmcnt(13)
    ds_read_b64_tr_b16 v[128:129], v22 offset:0
    ds_read_b64_tr_b16 v[132:133], v23 offset:0
    ds_read_b64_tr_b16 v[130:131], v22 offset:1024
    ds_read_b64_tr_b16 v[134:135], v23 offset:1024
    s_waitcnt vmcnt(11)
    ds_read_b64_tr_b16 v[136:137], v22 offset:2048
    ds_read_b64_tr_b16 v[140:141], v23 offset:2048
    ds_read_b64_tr_b16 v[138:139], v22 offset:3072
    ds_read_b64_tr_b16 v[142:143], v23 offset:3072
    s_waitcnt lgkmcnt(5)
    buffer_store_dwordx4 v[128:131], v24, s[48:51], s64 offen offset:0 sc1
    s_waitcnt lgkmcnt(4)
    buffer_store_dwordx4 v[132:135], v24, s[48:51], s64 offen offset:1024 sc1
    s_waitcnt vmcnt(11)
    ds_read_b64_tr_b16 v[144:145], v22 offset:4096
    ds_read_b64_tr_b16 v[148:149], v23 offset:4096
    ds_read_b64_tr_b16 v[146:147], v22 offset:5120
    ds_read_b64_tr_b16 v[150:151], v23 offset:5120
    s_lshr_b32 s75, s52, 0
    s_mul_i32 s75, s75, 10240
    s_add_u32 s64, s64, s75
    s_add_u32 s64, s64, 8192
    s_waitcnt lgkmcnt(5)
    buffer_store_dwordx4 v[136:139], v24, s[48:51], s64 offen offset:0 sc1
    s_waitcnt lgkmcnt(4)
    buffer_store_dwordx4 v[140:143], v24, s[48:51], s64 offen offset:1024 sc1
    s_waitcnt vmcnt(10)
    ds_read_b64_tr_b16 v[152:153], v22 offset:6144
    ds_read_b64_tr_b16 v[156:157], v23 offset:6144
    ds_read_b64_tr_b16 v[154:155], v22 offset:7168
    ds_read_b64_tr_b16 v[158:159], v23 offset:7168
    s_add_u32 s64, s64, 2048
    s_waitcnt lgkmcnt(5)
    buffer_store_dwordx4 v[144:147], v24, s[48:51], s64 offen offset:0 sc1
    s_waitcnt lgkmcnt(4)
    buffer_store_dwordx4 v[148:151], v24, s[48:51], s64 offen offset:1024 sc1
    s_waitcnt vmcnt(10)
    ds_read_b64_tr_b16 v[160:161], v22 offset:8192
    ds_read_b64_tr_b16 v[164:165], v23 offset:8192
    ds_read_b64_tr_b16 v[162:163], v22 offset:9216
    ds_read_b64_tr_b16 v[166:167], v23 offset:9216
    s_add_u32 s64, s64, 2048
    s_waitcnt lgkmcnt(5)
    buffer_store_dwordx4 v[152:155], v24, s[48:51], s64 offen offset:0 sc1
    s_waitcnt lgkmcnt(4)
    buffer_store_dwordx4 v[156:159], v24, s[48:51], s64 offen offset:1024 sc1
    s_waitcnt vmcnt(10)
    ds_read_b64_tr_b16 v[168:169], v22 offset:10240
    ds_read_b64_tr_b16 v[172:173], v23 offset:10240
    ds_read_b64_tr_b16 v[170:171], v22 offset:11264
    ds_read_b64_tr_b16 v[174:175], v23 offset:11264
    s_add_u32 s64, s64, 2048
    s_waitcnt lgkmcnt(5)
    buffer_store_dwordx4 v[160:163], v24, s[48:51], s64 offen offset:0 sc1
    s_waitcnt lgkmcnt(4)
    buffer_store_dwordx4 v[164:167], v24, s[48:51], s64 offen offset:1024 sc1
    s_waitcnt vmcnt(10)
    ds_read_b64_tr_b16 v[176:177], v22 offset:12288
    ds_read_b64_tr_b16 v[180:181], v23 offset:12288
    ds_read_b64_tr_b16 v[178:179], v22 offset:13312
    ds_read_b64_tr_b16 v[182:183], v23 offset:13312
    s_add_u32 s64, s64, 2048
    s_waitcnt lgkmcnt(5)
    buffer_store_dwordx4 v[168:171], v24, s[48:51], s64 offen offset:0 sc1
    s_waitcnt lgkmcnt(4)
    buffer_store_dwordx4 v[172:175], v24, s[48:51], s64 offen offset:1024 sc1
    s_add_u32 s64, s64, 2048
    s_waitcnt lgkmcnt(1)
    buffer_store_dwordx4 v[176:179], v24, s[48:51], s64 offen offset:0 sc1
    s_waitcnt lgkmcnt(0)
    buffer_store_dwordx4 v[180:183], v24, s[48:51], s64 offen offset:1024 sc1
    s_barrier
    ds_read_b64 v[32:33], v25 offset:0
    ds_read_b64 v[34:35], v25 offset:512
    ds_read_b64 v[36:37], v25 offset:1024
    ds_read_b64 v[38:39], v25 offset:1536
    s_waitcnt lgkmcnt(2)
    v_pk_add_f32 v[32:33], v[32:33], v[34:35]
    s_waitcnt lgkmcnt(1)
    v_pk_add_f32 v[32:33], v[32:33], v[36:37]
    s_waitcnt lgkmcnt(0)
    v_pk_add_f32 v[32:33], v[32:33], v[38:39]
    v_cvt_pk_bf16_f32 v41, v32, 0
    v_lshlrev_b32 v34, 16, v41
    v_sub_f32 v35, v32, v34
    v_cvt_pk_bf16_f32 v40, v34, v35
    v_cvt_pk_bf16_f32 v43, v33, 0
    v_lshlrev_b32 v34, 16, v43
    v_sub_f32 v35, v33, v34
    v_cvt_pk_bf16_f32 v42, v34, v35
    s_add_u32 s64, s66, 114688
    s_cmp_eq_u32 s52, 0
    s_cbranch_scc0 Lskip_38
    buffer_store_dwordx4 v[40:43], v24, s[48:51], s64 offen sc1
Lskip_38:
    s_waitcnt vmcnt(0)
    buffer_store_dword v2, v27, s[48:51], s73 offen offset:1024 sc1
    s_endpgm
L_tag:
L_exit:
    s_endpgm

.section .rodata,"a"
.p2align 6
.amdhsa_kernel parallel_sum__ssm_conv_h3__mixer_s_mlp__prompt_kernel
  .amdhsa_next_free_vgpr 512
  .amdhsa_next_free_sgpr 102
  .amdhsa_accum_offset 256
  .amdhsa_group_segment_fixed_size 0
  .amdhsa_kernarg_size 112
  .amdhsa_user_sgpr_count 2
  .amdhsa_user_sgpr_kernarg_segment_ptr 1
  .amdhsa_system_sgpr_workgroup_id_x 1
.end_amdhsa_kernel
.text
```
